```python
import torch

def _softmax(x, axis=-1):
    return torch.softmax(x, dim=axis)
def _gelu(x):
    return torch.nn.functional.gelu(x, approximate="tanh")
def _silu(x):
    return torch.nn.functional.silu(x)
def _sigmoid(x):
    return torch.sigmoid(x)
def _layernorm(x, axis=-1, eps=1e-5):
    m = x.mean(dim=axis, keepdim=True)
    v = x.var(dim=axis, keepdim=True, unbiased=False)
    return (x - m) / torch.sqrt(v + eps)
def _scatter_add(tgt, idx, src, axis=0):
    return tgt.clone().index_add_(axis, idx, src)
def _segment_sum(src, seg, n):
    out = torch.zeros((n,) + src.shape[1:], dtype=src.dtype)
    return out.index_add_(0, seg, src)
def _pad(x, pw):
    flat = tuple(v for pair in reversed(pw) for v in pair)
    return torch.nn.functional.pad(x, flat)

kernel_name = 'sequential_preLN__gqa_block_cached__geglu_ffn__decode'

def setup_inputs():

    _w = (lambda a: (lambda t: t.to(torch.bfloat16) if t.is_floating_point() else t)(torch.as_tensor(a)))
    def _A_setup():
        B, Sq, D = 4, 1, 512
        Hq, Hkv, Sk, Dh = 32, 32, 8192, 128
        assert Hq % Hkv == 0, (Hq, Hkv)
        return {
            "x": _w((lambda *s: torch.randn(*s, dtype=torch.bfloat16) * 0.05)(B, Sq, D)),
            "k_cache": _w((lambda *s: torch.randn(*s, dtype=torch.bfloat16) * 3.2)(B, Hkv, Sk, Dh)),
            "v_cache": _w((lambda *s: torch.randn(*s, dtype=torch.bfloat16) * 0.4)(B, Hkv, Sk, Dh)),
            "wq": _w((lambda *s: torch.randn(*s, dtype=torch.bfloat16) * 3.2)(D, Hq * Dh) * (D ** -0.5)),
            "wo": _w((lambda *s: torch.randn(*s, dtype=torch.bfloat16) * 0.4)(Hq * Dh, D) * ((Hq * Dh) ** -0.5)),
        }
    _A_in = _A_setup()

    def _B_setup():
        B, S, D, F = 4, 1, 512, 1376
        return {
            "x": _w((lambda *s: torch.randn(*s, dtype=torch.bfloat16) * 0.05)(B, S, D)),
            "w_gate": _w((lambda *s: torch.randn(*s, dtype=torch.bfloat16) * 0.05)(D, F)),
            "w_up": _w((lambda *s: torch.randn(*s, dtype=torch.bfloat16) * 0.05)(D, F)),
            "w_down": _w((lambda *s: torch.randn(*s, dtype=torch.bfloat16) * 0.05)(F, D)),
        }
    _B_in = _B_setup()

    return {
        "A_x": _A_in["x"],
        "A_k_cache": _A_in["k_cache"],
        "A_v_cache": _A_in["v_cache"],
        "A_wq": _A_in["wq"],
        "A_wo": _A_in["wo"],
        "B_x": _B_in["x"],
        "B_w_gate": _B_in["w_gate"],
        "B_w_up": _B_in["w_up"],
        "B_w_down": _B_in["w_down"],
    }

def reference(A_x, A_k_cache, A_v_cache, A_wq, A_wo, B_x, B_w_gate, B_w_up, B_w_down):
    def _A_ref(x, k_cache, v_cache, wq, wo):
        B, Sq, D = x.shape
        Hq, Dh = 32, 128
        Hkv = k_cache.shape[1]
        rep = Hq // Hkv
        q = (lambda x, *d: x.permute(*d))((x @ wq).reshape(B, Sq, Hq, Dh), 0, 2, 1, 3)
        k = (lambda x, n, axis: torch.repeat_interleave(x, n, dim=axis))(k_cache, rep, axis=1)
        v = (lambda x, n, axis: torch.repeat_interleave(x, n, dim=axis))(v_cache, rep, axis=1)
        scores = torch.einsum("bhqd,bhkd->bhqk", q, k) * (Dh ** -0.5)
        p = _softmax(scores, axis=-1)
        o = torch.einsum("bhqk,bhkd->bhqd", p, v)
        return (lambda x, *d: x.permute(*d))(o, 0, 2, 1, 3).reshape(B, Sq, Hq * Dh) @ wo

    def _B_ref(x, w_gate, w_up, w_down):
        return (_gelu(x @ w_gate) * (x @ w_up)) @ w_down

    x = A_x
    h = x + _A_ref(_layernorm(x, axis=-1), A_k_cache, A_v_cache, A_wq, A_wo)
    h2 = h + _B_ref(_layernorm(h, axis=-1), B_w_gate, B_w_up, B_w_down)
    return h2
```

```asm
; @launch grid=(256,1,1) block=(512,1,1) lds=145408
.amdgcn_target "amdgcn-amd-amdhsa--gfx950"
.text
.globl sequential_preLN__gqa_block_cached__geglu_ffn__decode_kernel
.p2align 8
.type sequential_preLN__gqa_block_cached__geglu_ffn__decode_kernel,@function
sequential_preLN__gqa_block_cached__geglu_ffn__decode_kernel:
  s_cmp_ge_u32 s2, 256
  s_cbranch_scc1 L_end
  s_load_dwordx16 s[16:31], s[0:1], 0
  s_load_dwordx8 s[32:39], s[0:1], 64
  s_mov_b32 s80, s2
  v_lshrrev_b32 v3, 6, v0
  v_and_b32 v2, 63, v0
  v_readfirstlane_b32 s3, v3
  s_and_b32 s60, s2, 7
  s_lshr_b32 s70, s2, 3
  s_and_b32 s70, s70, 3
  s_lshl_b32 s70, s70, 3
  s_add_u32 s60, s60, s70
  s_lshr_b32 s61, s2, 6
  s_lshr_b32 s62, s2, 5
  s_lshl_b32 s63, s61, 6
  s_lshl_b32 s70, s60, 1
  s_add_u32 s63, s63, s70
  s_and_b32 s70, s62, 1
  s_add_u32 s63, s63, s70
  s_lshl_b32 s63, s63, 20
  s_mov_b32 s64, s63
  s_add_u32 s70, s60, 32
  s_cmp_lt_u32 s60, 11
  s_cselect_b32 s70, s70, 255
  s_cselect_b32 s71, 6, 255
  s_cmp_eq_u32 s62, 6
  s_cselect_b32 s89, s70, 255
  s_cmp_eq_u32 s62, 7
  s_cselect_b32 s89, s60, s89
  s_cmp_eq_u32 s62, 1
  s_cselect_b32 s85, s71, 255
  s_cmp_eq_u32 s62, 0
  s_cselect_b32 s85, 7, s85
  v_lshrrev_b32 v36, 4, v2
  v_and_b32 v37, 15, v2
  s_cmp_lt_u32 s3, 4
  s_cbranch_scc1 L_S
  s_sub_u32 s84, s3, 4
  v_lshlrev_b32 v51, 2, v2
  v_mov_b32 v52, 0
  ds_write_b32 v51, v52 offset:20480
  ds_write_b32 v51, v52 offset:29120
  v_mov_b32 v52, 5
  s_mov_b64 exec, 0xff
  ds_write_b32 v51, v52 offset:29200
  s_mov_b64 exec, -1
  v_lshlrev_b32 v49, 4, v2
  v_lshl_add_u32 v50, v37, 2, v36
  v_lshlrev_b32 v50, 1, v50
  v_lshlrev_b32 v38, 13, v36
  v_lshl_add_u32 v38, v37, 4, v38
  s_mov_b32 s66, 0xcccccccc
  s_mov_b32 s67, 0xcccccccc
  s_mov_b32 s68, 0xaaaaaaaa
  s_mov_b32 s69, 0xaaaaaaaa
  s_mov_b32 s82, 0x3db504f3
  s_mov_b32 s83, 0x3fb8aa3b
  s_waitcnt lgkmcnt(0)
  s_load_dword s81, s[38:39], 0
  s_lshl_b32 s70, s84, 10
  s_add_u32 s48, s16, s70
  s_addc_u32 s49, s17, 0
  s_mov_b32 s50, 1024
  s_mov_b32 s51, 0x20000
  s_lshl_b32 s70, s60, 8
  s_add_u32 s44, s22, s70
  s_addc_u32 s45, s23, 0
  s_mov_b32 s46, 4194304
  s_mov_b32 s47, 0x20000
  s_sub_u32 s46, s46, s70
  buffer_load_dwordx4 v[44:47], v49, s[48:51], 0 offen
  s_lshl_b32 s70, s62, 7
  buffer_load_ushort v48, v50, s[48:51], s70 offen
  s_lshl_b32 s70, s62, 19
  buffer_load_dwordx4 v[160:163], v38, s[44:47], s70 offen nt
  s_add_u32 s70, s70, 32768
  buffer_load_dwordx4 v[164:167], v38, s[44:47], s70 offen nt
  s_add_u32 s70, s70, 32768
  buffer_load_dwordx4 v[168:171], v38, s[44:47], s70 offen nt
  s_add_u32 s70, s70, 32768
  buffer_load_dwordx4 v[172:175], v38, s[44:47], s70 offen nt
  s_add_u32 s70, s70, 32768
  buffer_load_dwordx4 v[176:179], v38, s[44:47], s70 offen nt
  s_add_u32 s70, s70, 32768
  buffer_load_dwordx4 v[180:183], v38, s[44:47], s70 offen nt
  s_add_u32 s70, s70, 32768
  buffer_load_dwordx4 v[184:187], v38, s[44:47], s70 offen nt
  s_add_u32 s70, s70, 32768
  buffer_load_dwordx4 v[188:191], v38, s[44:47], s70 offen nt
  s_add_u32 s70, s70, 32768
  buffer_load_dwordx4 v[192:195], v38, s[44:47], s70 offen nt
  s_add_u32 s70, s70, 32768
  buffer_load_dwordx4 v[196:199], v38, s[44:47], s70 offen nt
  s_add_u32 s70, s70, 32768
  buffer_load_dwordx4 v[200:203], v38, s[44:47], s70 offen nt
  s_add_u32 s70, s70, 32768
  buffer_load_dwordx4 v[204:207], v38, s[44:47], s70 offen nt
  s_add_u32 s70, s70, 32768
  buffer_load_dwordx4 v[208:211], v38, s[44:47], s70 offen nt
  s_add_u32 s70, s70, 32768
  buffer_load_dwordx4 v[212:215], v38, s[44:47], s70 offen nt
  s_add_u32 s70, s70, 32768
  buffer_load_dwordx4 v[216:219], v38, s[44:47], s70 offen nt
  s_add_u32 s70, s70, 32768
  buffer_load_dwordx4 v[220:223], v38, s[44:47], s70 offen nt
  s_barrier
  s_mov_b32 s52, s38
  s_mov_b32 s53, s39
  s_mov_b32 s54, 3473408
  s_mov_b32 s55, 0x20000
  s_waitcnt vmcnt(16)
  v_lshlrev_b32 v52, 16, v44
  v_and_b32 v53, 0xffff0000, v44
  v_lshlrev_b32 v54, 16, v45
  v_and_b32 v55, 0xffff0000, v45
  v_lshlrev_b32 v56, 16, v46
  v_and_b32 v57, 0xffff0000, v46
  v_lshlrev_b32 v58, 16, v47
  v_and_b32 v59, 0xffff0000, v47
  v_add_f32 v49, v52, v53
  v_add_f32 v50, v54, v55
  v_add_f32 v51, v56, v57
  v_add_f32 v60, v58, v59
  v_add_f32 v49, v49, v50
  v_add_f32 v51, v51, v60
  v_add_f32 v60, v49, v51
  s_nop 1
  v_add_f32_dpp v60, v60, v60 row_ror:8 row_mask:0xf bank_mask:0xf
  s_nop 1
  v_add_f32_dpp v60, v60, v60 row_ror:4 row_mask:0xf bank_mask:0xf
  s_nop 1
  v_add_f32_dpp v60, v60, v60 row_ror:2 row_mask:0xf bank_mask:0xf
  s_nop 1
  v_add_f32_dpp v60, v60, v60 row_ror:1 row_mask:0xf bank_mask:0xf
  v_mov_b32 v49, v60
  s_nop 1
  v_permlane16_swap_b32 v60, v49
  v_add_f32 v60, v60, v49
  v_mov_b32 v49, v60
  s_nop 1
  v_permlane32_swap_b32 v60, v49
  v_add_f32 v60, v60, v49
  v_mul_f32 v60, 0x3b000000, v60
  v_sub_f32 v49, v52, v60
  v_mul_f32 v61, v49, v49
  v_sub_f32 v49, v53, v60
  v_fmac_f32 v61, v49, v49
  v_sub_f32 v49, v54, v60
  v_fmac_f32 v61, v49, v49
  v_sub_f32 v49, v55, v60
  v_fmac_f32 v61, v49, v49
  v_sub_f32 v49, v56, v60
  v_fmac_f32 v61, v49, v49
  v_sub_f32 v49, v57, v60
  v_fmac_f32 v61, v49, v49
  v_sub_f32 v49, v58, v60
  v_fmac_f32 v61, v49, v49
  v_sub_f32 v49, v59, v60
  v_fmac_f32 v61, v49, v49
  s_nop 1
  v_add_f32_dpp v61, v61, v61 row_ror:8 row_mask:0xf bank_mask:0xf
  s_nop 1
  v_add_f32_dpp v61, v61, v61 row_ror:4 row_mask:0xf bank_mask:0xf
  s_nop 1
  v_add_f32_dpp v61, v61, v61 row_ror:2 row_mask:0xf bank_mask:0xf
  s_nop 1
  v_add_f32_dpp v61, v61, v61 row_ror:1 row_mask:0xf bank_mask:0xf
  v_mov_b32 v49, v61
  s_nop 1
  v_permlane16_swap_b32 v61, v49
  v_add_f32 v61, v61, v49
  v_mov_b32 v49, v61
  s_nop 1
  v_permlane32_swap_b32 v61, v49
  v_add_f32 v61, v61, v49
  v_mul_f32 v61, 0x3b000000, v61
  v_cvt_pk_bf16_f32 v61, v61, v61
  v_lshlrev_b32 v61, 16, v61
  v_add_f32 v61, 0x3727c5ac, v61
  v_cvt_pk_bf16_f32 v61, v61, v61
  v_lshlrev_b32 v61, 16, v61
  v_sqrt_f32 v61, v61
  s_nop 0
  v_cvt_pk_bf16_f32 v61, v61, v61
  v_lshlrev_b32 v61, 16, v61
  v_cvt_pk_bf16_f32 v60, v60, v60
  v_lshlrev_b32 v60, 16, v60
  v_lshlrev_b32 v48, 16, v48
  v_sub_f32 v48, v48, v60
  v_cvt_pk_bf16_f32 v48, v48, v48
  v_lshlrev_b32 v48, 16, v48
  v_rcp_f32 v49, v61
  s_nop 0
  v_mul_f32 v50, v48, v49
  v_fma_f32 v51, -v50, v61, v48
  v_fma_f32 v48, v51, v49, v50
  v_cvt_pk_bf16_f32 v16, v48, 0
  v_lshlrev_b32 v17, 16, v16
  v_mov_b32 v8, 0
  v_mov_b32 v9, 0
  v_mov_b32 v10, 0
  v_mov_b32 v11, 0
  v_mov_b32 v12, 0
  v_mov_b32 v13, 0
  v_mov_b32 v14, 0
  v_mov_b32 v15, 0
  s_waitcnt vmcnt(15)
  v_dot2c_f32_bf16_dpp v8, v16, v160 row_newbcast:0 row_mask:0xf bank_mask:0xf
  v_dot2c_f32_bf16_dpp v9, v17, v160 row_newbcast:0 row_mask:0xf bank_mask:0xf
  v_dot2c_f32_bf16_dpp v10, v16, v161 row_newbcast:0 row_mask:0xf bank_mask:0xf
  v_dot2c_f32_bf16_dpp v11, v17, v161 row_newbcast:0 row_mask:0xf bank_mask:0xf
  v_dot2c_f32_bf16_dpp v12, v16, v162 row_newbcast:0 row_mask:0xf bank_mask:0xf
  v_dot2c_f32_bf16_dpp v13, v17, v162 row_newbcast:0 row_mask:0xf bank_mask:0xf
  v_dot2c_f32_bf16_dpp v14, v16, v163 row_newbcast:0 row_mask:0xf bank_mask:0xf
  v_dot2c_f32_bf16_dpp v15, v17, v163 row_newbcast:0 row_mask:0xf bank_mask:0xf
  s_waitcnt vmcnt(14)
  v_dot2c_f32_bf16_dpp v8, v16, v164 row_newbcast:1 row_mask:0xf bank_mask:0xf
  v_dot2c_f32_bf16_dpp v9, v17, v164 row_newbcast:1 row_mask:0xf bank_mask:0xf
  v_dot2c_f32_bf16_dpp v10, v16, v165 row_newbcast:1 row_mask:0xf bank_mask:0xf
  v_dot2c_f32_bf16_dpp v11, v17, v165 row_newbcast:1 row_mask:0xf bank_mask:0xf
  v_dot2c_f32_bf16_dpp v12, v16, v166 row_newbcast:1 row_mask:0xf bank_mask:0xf
  v_dot2c_f32_bf16_dpp v13, v17, v166 row_newbcast:1 row_mask:0xf bank_mask:0xf
  v_dot2c_f32_bf16_dpp v14, v16, v167 row_newbcast:1 row_mask:0xf bank_mask:0xf
  v_dot2c_f32_bf16_dpp v15, v17, v167 row_newbcast:1 row_mask:0xf bank_mask:0xf
  s_waitcnt vmcnt(13)
  v_dot2c_f32_bf16_dpp v8, v16, v168 row_newbcast:2 row_mask:0xf bank_mask:0xf
  v_dot2c_f32_bf16_dpp v9, v17, v168 row_newbcast:2 row_mask:0xf bank_mask:0xf
  v_dot2c_f32_bf16_dpp v10, v16, v169 row_newbcast:2 row_mask:0xf bank_mask:0xf
  v_dot2c_f32_bf16_dpp v11, v17, v169 row_newbcast:2 row_mask:0xf bank_mask:0xf
  v_dot2c_f32_bf16_dpp v12, v16, v170 row_newbcast:2 row_mask:0xf bank_mask:0xf
  v_dot2c_f32_bf16_dpp v13, v17, v170 row_newbcast:2 row_mask:0xf bank_mask:0xf
  v_dot2c_f32_bf16_dpp v14, v16, v171 row_newbcast:2 row_mask:0xf bank_mask:0xf
  v_dot2c_f32_bf16_dpp v15, v17, v171 row_newbcast:2 row_mask:0xf bank_mask:0xf
  s_waitcnt vmcnt(12)
  v_dot2c_f32_bf16_dpp v8, v16, v172 row_newbcast:3 row_mask:0xf bank_mask:0xf
  v_dot2c_f32_bf16_dpp v9, v17, v172 row_newbcast:3 row_mask:0xf bank_mask:0xf
  v_dot2c_f32_bf16_dpp v10, v16, v173 row_newbcast:3 row_mask:0xf bank_mask:0xf
  v_dot2c_f32_bf16_dpp v11, v17, v173 row_newbcast:3 row_mask:0xf bank_mask:0xf
  v_dot2c_f32_bf16_dpp v12, v16, v174 row_newbcast:3 row_mask:0xf bank_mask:0xf
  v_dot2c_f32_bf16_dpp v13, v17, v174 row_newbcast:3 row_mask:0xf bank_mask:0xf
  v_dot2c_f32_bf16_dpp v14, v16, v175 row_newbcast:3 row_mask:0xf bank_mask:0xf
  v_dot2c_f32_bf16_dpp v15, v17, v175 row_newbcast:3 row_mask:0xf bank_mask:0xf
  s_waitcnt vmcnt(11)
  v_dot2c_f32_bf16_dpp v8, v16, v176 row_newbcast:4 row_mask:0xf bank_mask:0xf
  v_dot2c_f32_bf16_dpp v9, v17, v176 row_newbcast:4 row_mask:0xf bank_mask:0xf
  v_dot2c_f32_bf16_dpp v10, v16, v177 row_newbcast:4 row_mask:0xf bank_mask:0xf
  v_dot2c_f32_bf16_dpp v11, v17, v177 row_newbcast:4 row_mask:0xf bank_mask:0xf
  v_dot2c_f32_bf16_dpp v12, v16, v178 row_newbcast:4 row_mask:0xf bank_mask:0xf
  v_dot2c_f32_bf16_dpp v13, v17, v178 row_newbcast:4 row_mask:0xf bank_mask:0xf
  v_dot2c_f32_bf16_dpp v14, v16, v179 row_newbcast:4 row_mask:0xf bank_mask:0xf
  v_dot2c_f32_bf16_dpp v15, v17, v179 row_newbcast:4 row_mask:0xf bank_mask:0xf
  s_waitcnt vmcnt(10)
  v_dot2c_f32_bf16_dpp v8, v16, v180 row_newbcast:5 row_mask:0xf bank_mask:0xf
  v_dot2c_f32_bf16_dpp v9, v17, v180 row_newbcast:5 row_mask:0xf bank_mask:0xf
  v_dot2c_f32_bf16_dpp v10, v16, v181 row_newbcast:5 row_mask:0xf bank_mask:0xf
  v_dot2c_f32_bf16_dpp v11, v17, v181 row_newbcast:5 row_mask:0xf bank_mask:0xf
  v_dot2c_f32_bf16_dpp v12, v16, v182 row_newbcast:5 row_mask:0xf bank_mask:0xf
  v_dot2c_f32_bf16_dpp v13, v17, v182 row_newbcast:5 row_mask:0xf bank_mask:0xf
  v_dot2c_f32_bf16_dpp v14, v16, v183 row_newbcast:5 row_mask:0xf bank_mask:0xf
  v_dot2c_f32_bf16_dpp v15, v17, v183 row_newbcast:5 row_mask:0xf bank_mask:0xf
  s_waitcnt vmcnt(9)
  v_dot2c_f32_bf16_dpp v8, v16, v184 row_newbcast:6 row_mask:0xf bank_mask:0xf
  v_dot2c_f32_bf16_dpp v9, v17, v184 row_newbcast:6 row_mask:0xf bank_mask:0xf
  v_dot2c_f32_bf16_dpp v10, v16, v185 row_newbcast:6 row_mask:0xf bank_mask:0xf
  v_dot2c_f32_bf16_dpp v11, v17, v185 row_newbcast:6 row_mask:0xf bank_mask:0xf
  v_dot2c_f32_bf16_dpp v12, v16, v186 row_newbcast:6 row_mask:0xf bank_mask:0xf
  v_dot2c_f32_bf16_dpp v13, v17, v186 row_newbcast:6 row_mask:0xf bank_mask:0xf
  v_dot2c_f32_bf16_dpp v14, v16, v187 row_newbcast:6 row_mask:0xf bank_mask:0xf
  v_dot2c_f32_bf16_dpp v15, v17, v187 row_newbcast:6 row_mask:0xf bank_mask:0xf
  s_waitcnt vmcnt(8)
  v_dot2c_f32_bf16_dpp v8, v16, v188 row_newbcast:7 row_mask:0xf bank_mask:0xf
  v_dot2c_f32_bf16_dpp v9, v17, v188 row_newbcast:7 row_mask:0xf bank_mask:0xf
  v_dot2c_f32_bf16_dpp v10, v16, v189 row_newbcast:7 row_mask:0xf bank_mask:0xf
  v_dot2c_f32_bf16_dpp v11, v17, v189 row_newbcast:7 row_mask:0xf bank_mask:0xf
  v_dot2c_f32_bf16_dpp v12, v16, v190 row_newbcast:7 row_mask:0xf bank_mask:0xf
  v_dot2c_f32_bf16_dpp v13, v17, v190 row_newbcast:7 row_mask:0xf bank_mask:0xf
  v_dot2c_f32_bf16_dpp v14, v16, v191 row_newbcast:7 row_mask:0xf bank_mask:0xf
  v_dot2c_f32_bf16_dpp v15, v17, v191 row_newbcast:7 row_mask:0xf bank_mask:0xf
  s_waitcnt vmcnt(7)
  v_dot2c_f32_bf16_dpp v8, v16, v192 row_newbcast:8 row_mask:0xf bank_mask:0xf
  v_dot2c_f32_bf16_dpp v9, v17, v192 row_newbcast:8 row_mask:0xf bank_mask:0xf
  v_dot2c_f32_bf16_dpp v10, v16, v193 row_newbcast:8 row_mask:0xf bank_mask:0xf
  v_dot2c_f32_bf16_dpp v11, v17, v193 row_newbcast:8 row_mask:0xf bank_mask:0xf
  v_dot2c_f32_bf16_dpp v12, v16, v194 row_newbcast:8 row_mask:0xf bank_mask:0xf
  v_dot2c_f32_bf16_dpp v13, v17, v194 row_newbcast:8 row_mask:0xf bank_mask:0xf
  v_dot2c_f32_bf16_dpp v14, v16, v195 row_newbcast:8 row_mask:0xf bank_mask:0xf
  v_dot2c_f32_bf16_dpp v15, v17, v195 row_newbcast:8 row_mask:0xf bank_mask:0xf
  s_waitcnt vmcnt(6)
  v_dot2c_f32_bf16_dpp v8, v16, v196 row_newbcast:9 row_mask:0xf bank_mask:0xf
  v_dot2c_f32_bf16_dpp v9, v17, v196 row_newbcast:9 row_mask:0xf bank_mask:0xf
  v_dot2c_f32_bf16_dpp v10, v16, v197 row_newbcast:9 row_mask:0xf bank_mask:0xf
  v_dot2c_f32_bf16_dpp v11, v17, v197 row_newbcast:9 row_mask:0xf bank_mask:0xf
  v_dot2c_f32_bf16_dpp v12, v16, v198 row_newbcast:9 row_mask:0xf bank_mask:0xf
  v_dot2c_f32_bf16_dpp v13, v17, v198 row_newbcast:9 row_mask:0xf bank_mask:0xf
  v_dot2c_f32_bf16_dpp v14, v16, v199 row_newbcast:9 row_mask:0xf bank_mask:0xf
  v_dot2c_f32_bf16_dpp v15, v17, v199 row_newbcast:9 row_mask:0xf bank_mask:0xf
  s_waitcnt vmcnt(5)
  v_dot2c_f32_bf16_dpp v8, v16, v200 row_newbcast:10 row_mask:0xf bank_mask:0xf
  v_dot2c_f32_bf16_dpp v9, v17, v200 row_newbcast:10 row_mask:0xf bank_mask:0xf
  v_dot2c_f32_bf16_dpp v10, v16, v201 row_newbcast:10 row_mask:0xf bank_mask:0xf
  v_dot2c_f32_bf16_dpp v11, v17, v201 row_newbcast:10 row_mask:0xf bank_mask:0xf
  v_dot2c_f32_bf16_dpp v12, v16, v202 row_newbcast:10 row_mask:0xf bank_mask:0xf
  v_dot2c_f32_bf16_dpp v13, v17, v202 row_newbcast:10 row_mask:0xf bank_mask:0xf
  v_dot2c_f32_bf16_dpp v14, v16, v203 row_newbcast:10 row_mask:0xf bank_mask:0xf
  v_dot2c_f32_bf16_dpp v15, v17, v203 row_newbcast:10 row_mask:0xf bank_mask:0xf
  s_waitcnt vmcnt(4)
  v_dot2c_f32_bf16_dpp v8, v16, v204 row_newbcast:11 row_mask:0xf bank_mask:0xf
  v_dot2c_f32_bf16_dpp v9, v17, v204 row_newbcast:11 row_mask:0xf bank_mask:0xf
  v_dot2c_f32_bf16_dpp v10, v16, v205 row_newbcast:11 row_mask:0xf bank_mask:0xf
  v_dot2c_f32_bf16_dpp v11, v17, v205 row_newbcast:11 row_mask:0xf bank_mask:0xf
  v_dot2c_f32_bf16_dpp v12, v16, v206 row_newbcast:11 row_mask:0xf bank_mask:0xf
  v_dot2c_f32_bf16_dpp v13, v17, v206 row_newbcast:11 row_mask:0xf bank_mask:0xf
  v_dot2c_f32_bf16_dpp v14, v16, v207 row_newbcast:11 row_mask:0xf bank_mask:0xf
  v_dot2c_f32_bf16_dpp v15, v17, v207 row_newbcast:11 row_mask:0xf bank_mask:0xf
  s_waitcnt vmcnt(3)
  v_dot2c_f32_bf16_dpp v8, v16, v208 row_newbcast:12 row_mask:0xf bank_mask:0xf
  v_dot2c_f32_bf16_dpp v9, v17, v208 row_newbcast:12 row_mask:0xf bank_mask:0xf
  v_dot2c_f32_bf16_dpp v10, v16, v209 row_newbcast:12 row_mask:0xf bank_mask:0xf
  v_dot2c_f32_bf16_dpp v11, v17, v209 row_newbcast:12 row_mask:0xf bank_mask:0xf
  v_dot2c_f32_bf16_dpp v12, v16, v210 row_newbcast:12 row_mask:0xf bank_mask:0xf
  v_dot2c_f32_bf16_dpp v13, v17, v210 row_newbcast:12 row_mask:0xf bank_mask:0xf
  v_dot2c_f32_bf16_dpp v14, v16, v211 row_newbcast:12 row_mask:0xf bank_mask:0xf
  v_dot2c_f32_bf16_dpp v15, v17, v211 row_newbcast:12 row_mask:0xf bank_mask:0xf
  s_waitcnt vmcnt(2)
  v_dot2c_f32_bf16_dpp v8, v16, v212 row_newbcast:13 row_mask:0xf bank_mask:0xf
  v_dot2c_f32_bf16_dpp v9, v17, v212 row_newbcast:13 row_mask:0xf bank_mask:0xf
  v_dot2c_f32_bf16_dpp v10, v16, v213 row_newbcast:13 row_mask:0xf bank_mask:0xf
  v_dot2c_f32_bf16_dpp v11, v17, v213 row_newbcast:13 row_mask:0xf bank_mask:0xf
  v_dot2c_f32_bf16_dpp v12, v16, v214 row_newbcast:13 row_mask:0xf bank_mask:0xf
  v_dot2c_f32_bf16_dpp v13, v17, v214 row_newbcast:13 row_mask:0xf bank_mask:0xf
  v_dot2c_f32_bf16_dpp v14, v16, v215 row_newbcast:13 row_mask:0xf bank_mask:0xf
  v_dot2c_f32_bf16_dpp v15, v17, v215 row_newbcast:13 row_mask:0xf bank_mask:0xf
  s_waitcnt vmcnt(1)
  v_dot2c_f32_bf16_dpp v8, v16, v216 row_newbcast:14 row_mask:0xf bank_mask:0xf
  v_dot2c_f32_bf16_dpp v9, v17, v216 row_newbcast:14 row_mask:0xf bank_mask:0xf
  v_dot2c_f32_bf16_dpp v10, v16, v217 row_newbcast:14 row_mask:0xf bank_mask:0xf
  v_dot2c_f32_bf16_dpp v11, v17, v217 row_newbcast:14 row_mask:0xf bank_mask:0xf
  v_dot2c_f32_bf16_dpp v12, v16, v218 row_newbcast:14 row_mask:0xf bank_mask:0xf
  v_dot2c_f32_bf16_dpp v13, v17, v218 row_newbcast:14 row_mask:0xf bank_mask:0xf
  v_dot2c_f32_bf16_dpp v14, v16, v219 row_newbcast:14 row_mask:0xf bank_mask:0xf
  v_dot2c_f32_bf16_dpp v15, v17, v219 row_newbcast:14 row_mask:0xf bank_mask:0xf
  s_waitcnt vmcnt(0)
  v_dot2c_f32_bf16_dpp v8, v16, v220 row_newbcast:15 row_mask:0xf bank_mask:0xf
  v_dot2c_f32_bf16_dpp v9, v17, v220 row_newbcast:15 row_mask:0xf bank_mask:0xf
  v_dot2c_f32_bf16_dpp v10, v16, v221 row_newbcast:15 row_mask:0xf bank_mask:0xf
  v_dot2c_f32_bf16_dpp v11, v17, v221 row_newbcast:15 row_mask:0xf bank_mask:0xf
  v_dot2c_f32_bf16_dpp v12, v16, v222 row_newbcast:15 row_mask:0xf bank_mask:0xf
  v_dot2c_f32_bf16_dpp v13, v17, v222 row_newbcast:15 row_mask:0xf bank_mask:0xf
  v_dot2c_f32_bf16_dpp v14, v16, v223 row_newbcast:15 row_mask:0xf bank_mask:0xf
  v_dot2c_f32_bf16_dpp v15, v17, v223 row_newbcast:15 row_mask:0xf bank_mask:0xf
  v_permlane32_swap_b32 v8, v12
  v_permlane32_swap_b32 v9, v13
  v_permlane32_swap_b32 v10, v14
  v_permlane32_swap_b32 v11, v15
  v_add_f32 v8, v8, v12
  v_add_f32 v9, v9, v13
  v_add_f32 v10, v10, v14
  v_add_f32 v11, v11, v15
  s_nop 0
  v_permlane16_swap_b32 v8, v10
  v_permlane16_swap_b32 v9, v11
  v_add_f32 v8, v8, v10
  v_add_f32 v9, v9, v11
  s_waitcnt lgkmcnt(0)
  s_add_u32 s81, s81, 1
  v_mov_b32 v10, v9
  v_mov_b32 v9, s81
  v_mov_b32 v11, s81
  v_lshlrev_b32 v49, 6, v37
  v_lshl_add_u32 v49, v36, 4, v49
  s_lshl_b32 s70, s60, 2
  s_add_u32 s70, s70, s84
  s_lshl_b32 s70, s70, 3
  s_add_u32 s70, s70, s62
  s_lshl_b32 s70, s70, 10
  s_add_u32 s70, s70, 65536
  buffer_store_dwordx4 v[8:11], v49, s[52:55], s70 offen sc1 nt
  s_lshl_b32 s70, s60, 2
  s_add_u32 s70, s70, s61
  s_lshl_b32 s70, s70, 3
  s_lshl_b32 s71, s84, 1
  s_add_u32 s70, s70, s71
  s_lshl_b32 s70, s70, 10
  s_add_u32 s70, s70, 65536
  v_lshlrev_b32 v49, 4, v2
  s_waitcnt vmcnt(0)
  s_sleep 8
  s_mov_b32 s86, 0
L_npoll_1:
  buffer_load_dwordx4 v[20:23], v49, s[52:55], s70 offen sc1 nt
  buffer_load_dwordx4 v[24:27], v49, s[52:55], s70 offen offset:1024 sc1 nt
  s_waitcnt vmcnt(0)
  v_xor_b32 v61, s81, v21
  v_bitop3_b32 v61, v61, v23, s81 bitop3:0xf6
  v_bitop3_b32 v61, v61, v25, s81 bitop3:0xf6
  v_bitop3_b32 v61, v61, v27, s81 bitop3:0xf6
  v_cmp_ne_u32 vcc, 0, v61
  s_nop 0
  s_cmp_eq_u64 vcc, 0
  s_cbranch_scc1 L_npok_2
  s_mov_b64 exec, vcc
  s_add_u32 s86, s86, 1
  s_sleep 8
  s_cmp_le_u32 s86, 0x20000
  s_cbranch_scc1 L_npoll_1
L_npok_2:
  s_mov_b64 exec, -1
  v_add_f32 v20, v20, v24
  v_add_f32 v21, v22, v26
  s_lshl_b32 s70, s84, 9
  v_lshlrev_b32 v49, 3, v2
  v_add_u32 v50, s70, v49
  ds_write_b64 v50, v[20:21] offset:0
  s_waitcnt lgkmcnt(0)
  s_barrier
  s_cmp_lg_u32 s3, 7
  s_cbranch_scc1 L_nozero
  s_cmp_lg_u32 s80, 0
  s_cbranch_scc1 L_nozero
  v_mov_b32 v20, 0
  v_mov_b32 v21, 0
  v_mov_b32 v22, 0
  v_mov_b32 v23, 0
  v_lshlrev_b32 v46, 4, v2
  s_mov_b32 s70, 8192
  buffer_store_dwordx4 v[20:23], v46, s[52:55], s70 offen sc1
  s_add_u32 s70, s70, 1024
  buffer_store_dwordx4 v[20:23], v46, s[52:55], s70 offen sc1
  s_add_u32 s70, s70, 1024
  buffer_store_dwordx4 v[20:23], v46, s[52:55], s70 offen sc1
  s_add_u32 s70, s70, 1024
  buffer_store_dwordx4 v[20:23], v46, s[52:55], s70 offen sc1
  s_add_u32 s70, s70, 1024
  buffer_store_dwordx4 v[20:23], v46, s[52:55], s70 offen sc1
  s_add_u32 s70, s70, 1024
  buffer_store_dwordx4 v[20:23], v46, s[52:55], s70 offen sc1
  s_add_u32 s70, s70, 1024
  buffer_store_dwordx4 v[20:23], v46, s[52:55], s70 offen sc1
  s_add_u32 s70, s70, 1024
  buffer_store_dwordx4 v[20:23], v46, s[52:55], s70 offen sc1
  s_add_u32 s70, s70, 1024
  buffer_store_dwordx4 v[20:23], v46, s[52:55], s70 offen sc1
  s_add_u32 s70, s70, 1024
  buffer_store_dwordx4 v[20:23], v46, s[52:55], s70 offen sc1
  s_add_u32 s70, s70, 1024
  buffer_store_dwordx4 v[20:23], v46, s[52:55], s70 offen sc1
  s_add_u32 s70, s70, 1024
  buffer_store_dwordx4 v[20:23], v46, s[52:55], s70 offen sc1
  s_add_u32 s70, s70, 1024
  buffer_store_dwordx4 v[20:23], v46, s[52:55], s70 offen sc1
  s_add_u32 s70, s70, 1024
  buffer_store_dwordx4 v[20:23], v46, s[52:55], s70 offen sc1
  s_add_u32 s70, s70, 1024
  buffer_store_dwordx4 v[20:23], v46, s[52:55], s70 offen sc1
  s_add_u32 s70, s70, 1024
  buffer_store_dwordx4 v[20:23], v46, s[52:55], s70 offen sc1
  s_add_u32 s70, s70, 1024
  buffer_store_dwordx4 v[20:23], v46, s[52:55], s70 offen sc1
  s_add_u32 s70, s70, 1024
  buffer_store_dwordx4 v[20:23], v46, s[52:55], s70 offen sc1
  s_add_u32 s70, s70, 1024
  buffer_store_dwordx4 v[20:23], v46, s[52:55], s70 offen sc1
  s_add_u32 s70, s70, 1024
  buffer_store_dwordx4 v[20:23], v46, s[52:55], s70 offen sc1
  s_add_u32 s70, s70, 1024
  buffer_store_dwordx4 v[20:23], v46, s[52:55], s70 offen sc1
  s_add_u32 s70, s70, 1024
  buffer_store_dwordx4 v[20:23], v46, s[52:55], s70 offen sc1
  s_add_u32 s70, s70, 1024
  buffer_store_dwordx4 v[20:23], v46, s[52:55], s70 offen sc1
  s_add_u32 s70, s70, 1024
  buffer_store_dwordx4 v[20:23], v46, s[52:55], s70 offen sc1
  s_add_u32 s70, s70, 1024
  buffer_store_dwordx4 v[20:23], v46, s[52:55], s70 offen sc1
  s_add_u32 s70, s70, 1024
  buffer_store_dwordx4 v[20:23], v46, s[52:55], s70 offen sc1
  s_add_u32 s70, s70, 1024
  buffer_store_dwordx4 v[20:23], v46, s[52:55], s70 offen sc1
  s_add_u32 s70, s70, 1024
  buffer_store_dwordx4 v[20:23], v46, s[52:55], s70 offen sc1
  s_add_u32 s70, s70, 1024
  buffer_store_dwordx4 v[20:23], v46, s[52:55], s70 offen sc1
  s_add_u32 s70, s70, 1024
  buffer_store_dwordx4 v[20:23], v46, s[52:55], s70 offen sc1
  s_add_u32 s70, s70, 1024
  buffer_store_dwordx4 v[20:23], v46, s[52:55], s70 offen sc1
  s_add_u32 s70, s70, 1024
  buffer_store_dwordx4 v[20:23], v46, s[52:55], s70 offen sc1
  s_add_u32 s70, s70, 1024
  s_waitcnt vmcnt(0)
  v_mov_b32 v20, s81
  v_lshlrev_b32 v46, 7, v2
  s_mov_b32 s70, 1245184
  buffer_store_dword v20, v46, s[52:55], s70 offen sc1 nt
  s_add_u32 s70, s70, 8192
  buffer_store_dword v20, v46, s[52:55], s70 offen sc1 nt
  s_add_u32 s70, s70, 8192
  buffer_store_dword v20, v46, s[52:55], s70 offen sc1 nt
  s_add_u32 s70, s70, 8192
  buffer_store_dword v20, v46, s[52:55], s70 offen sc1 nt
  s_add_u32 s70, s70, 8192
L_nozero:
  s_mov_b32 s88, s84
  s_cmp_eq_u32 s3, 7
  s_cbranch_scc1 L_ctl
  s_cmp_eq_u32 s3, 6
  s_cbranch_scc1 L_lw
  s_cmp_eq_u32 s3, 5
  s_cbranch_scc1 L_wox5
  s_cmp_lt_u32 s89, 43
  s_cbranch_scc1 L_lw
  s_branch L_lw
L_wox5:
  s_cmp_gt_u32 s85, 7
  s_cbranch_scc1 L_lw
L_lw:
  s_lshl_b32 s70, s88, 3
  v_mov_b32 v46, s70
  s_mov_b32 s86, 0
L_poll_3:
  ds_read_b64 v[44:45], v46 offset:20576
  s_waitcnt lgkmcnt(0)
  v_cmp_ne_u32 vcc, 1, v45
  s_nop 0
  s_cmp_eq_u64 vcc, 0
  s_cbranch_scc1 L_pok_4
  s_add_u32 s86, s86, 1
  s_cmp_gt_u32 s86, 0x20000
  s_cbranch_scc1 L_pok_4
  s_sleep 16
  s_branch L_poll_3
L_pok_4:
  s_lshl_b32 s70, s88, 12
  v_lshlrev_b32 v47, 2, v2
  v_add_u32 v47, s70, v47
  ds_read_b32 v20, v47 offset:4096
  ds_read_b32 v21, v47 offset:4352
  ds_read_b32 v22, v47 offset:4608
  ds_read_b32 v23, v47 offset:4864
  ds_read_b32 v24, v47 offset:5120
  ds_read_b32 v25, v47 offset:5376
  ds_read_b32 v26, v47 offset:5632
  ds_read_b32 v27, v47 offset:5888
  ds_read_b32 v28, v47 offset:6144
  ds_read_b32 v29, v47 offset:6400
  ds_read_b32 v30, v47 offset:6656
  ds_read_b32 v31, v47 offset:6912
  ds_read_b32 v32, v47 offset:7168
  ds_read_b32 v33, v47 offset:7424
  ds_read_b32 v34, v47 offset:7680
  ds_read_b32 v35, v47 offset:7936
  s_waitcnt lgkmcnt(0)
  v_fma_f32 v20, v20, s83, -v44
  v_fma_f32 v21, v21, s83, -v44
  v_fma_f32 v22, v22, s83, -v44
  v_fma_f32 v23, v23, s83, -v44
  v_fma_f32 v24, v24, s83, -v44
  v_fma_f32 v25, v25, s83, -v44
  v_fma_f32 v26, v26, s83, -v44
  v_fma_f32 v27, v27, s83, -v44
  v_fma_f32 v28, v28, s83, -v44
  v_fma_f32 v29, v29, s83, -v44
  v_fma_f32 v30, v30, s83, -v44
  v_fma_f32 v31, v31, s83, -v44
  v_fma_f32 v32, v32, s83, -v44
  v_fma_f32 v33, v33, s83, -v44
  v_fma_f32 v34, v34, s83, -v44
  v_fma_f32 v35, v35, s83, -v44
  v_exp_f32 v20, v20
  v_exp_f32 v21, v21
  v_exp_f32 v22, v22
  v_exp_f32 v23, v23
  v_exp_f32 v24, v24
  v_exp_f32 v25, v25
  v_exp_f32 v26, v26
  v_exp_f32 v27, v27
  v_exp_f32 v28, v28
  v_exp_f32 v29, v29
  v_exp_f32 v30, v30
  v_exp_f32 v31, v31
  v_exp_f32 v32, v32
  v_exp_f32 v33, v33
  v_exp_f32 v34, v34
  v_exp_f32 v35, v35
  v_add_f32 v20, v20, v28
  v_add_f32 v21, v21, v29
  v_add_f32 v22, v22, v30
  v_add_f32 v23, v23, v31
  v_add_f32 v24, v24, v32
  v_add_f32 v25, v25, v33
  v_add_f32 v26, v26, v34
  v_add_f32 v27, v27, v35
  v_add_f32 v20, v20, v24
  v_add_f32 v21, v21, v25
  v_add_f32 v22, v22, v26
  v_add_f32 v23, v23, v27
  v_add_f32 v20, v20, v22
  v_add_f32 v21, v21, v23
  v_add_f32 v20, v20, v21
  s_nop 1
  v_add_f32_dpp v20, v20, v20 row_ror:8 row_mask:0xf bank_mask:0xf
  s_nop 1
  v_add_f32_dpp v20, v20, v20 row_ror:4 row_mask:0xf bank_mask:0xf
  s_nop 1
  v_add_f32_dpp v20, v20, v20 row_ror:2 row_mask:0xf bank_mask:0xf
  s_nop 1
  v_add_f32_dpp v20, v20, v20 row_ror:1 row_mask:0xf bank_mask:0xf
  v_mov_b32 v48, v20
  s_nop 1
  v_permlane16_swap_b32 v20, v48
  v_add_f32 v20, v20, v48
  v_mov_b32 v48, v20
  s_nop 1
  v_permlane32_swap_b32 v20, v48
  v_add_f32 v20, v20, v48
  v_mov_b32 v45, v20
  v_mov_b32 v46, 1
  v_mov_b32 v47, 1
  s_lshl_b32 s70, s88, 4
  v_mov_b32 v48, s70
  ds_write_b128 v48, v[44:47] offset:20480
  s_cmp_eq_u32 s88, 1
  s_cselect_b32 s88, 3, s88
  s_cbranch_scc1 L_lw
  s_cmp_lg_u32 s3, 4
  s_cbranch_scc1 L_H_dma
  v_and_b32 v46, 3, v2
  v_lshlrev_b32 v46, 4, v46
  s_mov_b32 s86, 0
L_poll_5:
  ds_read_b128 v[20:23], v46 offset:20480
  s_waitcnt lgkmcnt(0)
  v_cmp_ne_u32 vcc, 1, v22
  s_nop 0
  s_cmp_eq_u64 vcc, 0
  s_cbranch_scc1 L_pok_6
  s_add_u32 s86, s86, 1
  s_cmp_gt_u32 s86, 0x20000
  s_cbranch_scc1 L_pok_6
  s_sleep 8
  s_branch L_poll_5
L_pok_6:
  v_max_f32_dpp v24, v20, v20 quad_perm:[1,0,3,2] row_mask:0xf bank_mask:0xf
  s_nop 1
  v_max_f32_dpp v24, v24, v24 quad_perm:[2,3,0,1] row_mask:0xf bank_mask:0xf
  v_sub_f32 v25, v20, v24
  v_exp_f32 v25, v25
  s_nop 0
  v_mul_f32 v25, v25, v21
  s_nop 1
  v_add_f32_dpp v25, v25, v25 quad_perm:[1,0,3,2] row_mask:0xf bank_mask:0xf
  s_nop 1
  v_add_f32_dpp v25, v25, v25 quad_perm:[2,3,0,1] row_mask:0xf bank_mask:0xf
  v_mov_b32 v28, v24
  v_mov_b32 v29, s81
  v_mov_b32 v30, v25
  v_mov_b32 v31, s81
  s_lshl_b32 s70, s80, 7
  s_add_u32 s70, s70, 1179648
  v_mov_b32 v47, 0
  s_mov_b64 exec, 1
  buffer_store_dwordx4 v[28:31], v47, s[52:55], s70 offen sc1 nt
  s_mov_b64 exec, -1
  v_mov_b32 v46, 0
  s_mov_b32 s86, 0
L_poll_7:
  ds_read_b32 v48, v46 offset:20640
  s_waitcnt lgkmcnt(0)
  v_cmp_ne_u32 vcc, 1, v48
  s_nop 0
  s_cmp_eq_u64 vcc, 0
  s_cbranch_scc1 L_pok_8
  s_add_u32 s86, s86, 1
  s_cmp_gt_u32 s86, 0x20000
  s_cbranch_scc1 L_pok_8
  s_sleep 16
  s_branch L_poll_7
L_pok_8:
  s_xor_b32 s70, s80, 32
  s_lshl_b32 s70, s70, 7
  s_add_u32 s70, s70, 1179648
  s_add_u32 s72, s38, s70
  s_addc_u32 s73, s39, 0
  s_load_dwordx4 s[76:79], s[72:73], 0 glc
  s_waitcnt lgkmcnt(0)
  v_mov_b32 v32, s76
  v_mov_b32 v33, s77
  v_mov_b32 v34, s78
  v_mov_b32 v35, s79
  v_xor_b32 v61, s81, v33
  v_bitop3_b32 v61, v61, v35, s81 bitop3:0xf6
  v_cmp_ne_u32 vcc, 0, v61
  s_nop 0
  s_cmp_eq_u64 vcc, 0
  s_cbranch_scc1 L_ml_ok
  s_mov_b32 s86, 0
L_poll_9:
  buffer_load_dwordx4 v[32:35], v47, s[52:55], s70 offen sc1
  s_waitcnt vmcnt(0)
  v_xor_b32 v61, s81, v33
  v_bitop3_b32 v61, v61, v35, s81 bitop3:0xf6
  v_cmp_ne_u32 vcc, 0, v61
  s_nop 0
  s_cmp_eq_u64 vcc, 0
  s_cbranch_scc1 L_pok_10
  s_add_u32 s86, s86, 1
  s_cmp_gt_u32 s86, 0x20000
  s_cbranch_scc1 L_pok_10
  s_sleep 32
  s_branch L_poll_9
L_pok_10:
L_ml_ok:
  v_and_b32 v46, 3, v2
  v_lshlrev_b32 v46, 4, v46
  v_max_f32 v26, v24, v32
  v_sub_f32 v24, v24, v26
  v_sub_f32 v32, v32, v26
  v_sub_f32 v20, v20, v26
  v_exp_f32 v24, v24
  v_exp_f32 v32, v32
  v_exp_f32 v20, v20
  v_mul_f32 v25, v25, v24
  v_fmac_f32 v25, v34, v32
  v_rcp_f32 v27, v25
  s_nop 0
  v_mul_f32 v28, v20, v27
  v_fma_f32 v29, -v28, v25, v20
  v_fma_f32 v22, v29, v27, v28
  v_mov_b32 v23, 1
  v_lshrrev_b32 v46, 1, v46
  ds_write_b64 v46, v[22:23] offset:20544
  s_lshl_b32 s70, s80, 7
  s_add_u32 s70, s70, 1245184
  s_add_u32 s72, s38, s70
  s_addc_u32 s73, s39, 0
  s_load_dword s74, s[72:73], 0 glc
  s_waitcnt lgkmcnt(0)
  s_cmp_eq_u32 s74, s81
  s_cbranch_scc1 L_H_zok
  v_mov_b32 v47, 0
  s_mov_b32 s86, 0
L_poll_11:
  buffer_load_dword v48, v47, s[52:55], s70 offen sc1
  s_waitcnt vmcnt(0)
  v_cmp_ne_u32 vcc, s81, v48
  s_nop 0
  s_cmp_eq_u64 vcc, 0
  s_cbranch_scc1 L_pok_12
  s_add_u32 s86, s86, 1
  s_cmp_gt_u32 s86, 0x20000
  s_cbranch_scc1 L_pok_12
  s_sleep 16
  s_branch L_poll_11
L_pok_12:
L_H_zok:
  s_cmp_lt_u32 s89, 43
  s_cbranch_scc1 L_H_rpub
  v_mov_b32 v49, 0
  s_mov_b32 s86, 0
L_wt_13:
  ds_read_b128 v[20:23], v49 offset:29184
  s_waitcnt lgkmcnt(0)
  v_min_u32 v20, v20, v21
  v_min3_u32 v20, v20, v22, v23
  s_nop 0
  v_readfirstlane_b32 s70, v20
  s_nop 0
  s_cmp_ge_u32 s70, 253
  s_cbranch_scc1 L_wtk_14
  s_add_u32 s86, s86, 1
  s_cmp_gt_u32 s86, 0x40000
  s_cbranch_scc1 L_wtk_14
  s_sleep 3
  s_branch L_wt_13
L_wtk_14:
  s_mov_b32 s44, s24
  s_mov_b32 s45, s25
  s_mov_b32 s46, 4194304
  s_mov_b32 s47, 0x20000
  v_lshrrev_b32 v46, 3, v2
  v_lshlrev_b32 v46, 10, v46
  v_and_b32 v47, 7, v2
  v_lshl_add_u32 v46, v47, 4, v46
  s_lshl_b32 s70, s60, 17
  s_lshl_b32 s71, s62, 7
  s_add_u32 s70, s70, s71
  s_mov_b32 m0, 29696
  s_add_u32 s71, s70, 0
  buffer_load_dwordx4 v46, s[44:47], s71 offen nt lds
  s_mov_b32 m0, 30720
  s_add_u32 s71, s70, 8192
  buffer_load_dwordx4 v46, s[44:47], s71 offen nt lds
  s_mov_b32 m0, 31744
  s_add_u32 s71, s70, 16384
  buffer_load_dwordx4 v46, s[44:47], s71 offen nt lds
  s_mov_b32 m0, 32768
  s_add_u32 s71, s70, 24576
  buffer_load_dwordx4 v46, s[44:47], s71 offen nt lds
  s_mov_b32 m0, 33792
  s_add_u32 s71, s70, 32768
  buffer_load_dwordx4 v46, s[44:47], s71 offen nt lds
  s_mov_b32 m0, 34816
  s_add_u32 s71, s70, 40960
  buffer_load_dwordx4 v46, s[44:47], s71 offen nt lds
  s_mov_b32 m0, 35840
  s_add_u32 s71, s70, 49152
  buffer_load_dwordx4 v46, s[44:47], s71 offen nt lds
  s_mov_b32 m0, 36864
  s_add_u32 s71, s70, 57344
  buffer_load_dwordx4 v46, s[44:47], s71 offen nt lds
  s_mov_b32 m0, 37888
  s_add_u32 s71, s70, 65536
  buffer_load_dwordx4 v46, s[44:47], s71 offen nt lds
  s_mov_b32 m0, 38912
  s_add_u32 s71, s70, 73728
  buffer_load_dwordx4 v46, s[44:47], s71 offen nt lds
  s_mov_b32 m0, 39936
  s_add_u32 s71, s70, 81920
  buffer_load_dwordx4 v46, s[44:47], s71 offen nt lds
  s_mov_b32 m0, 40960
  s_add_u32 s71, s70, 90112
  buffer_load_dwordx4 v46, s[44:47], s71 offen nt lds
  s_mov_b32 m0, 41984
  s_add_u32 s71, s70, 98304
  buffer_load_dwordx4 v46, s[44:47], s71 offen nt lds
  s_mov_b32 m0, 43008
  s_add_u32 s71, s70, 106496
  buffer_load_dwordx4 v46, s[44:47], s71 offen nt lds
  s_mov_b32 m0, 44032
  s_add_u32 s71, s70, 114688
  buffer_load_dwordx4 v46, s[44:47], s71 offen nt lds
  s_mov_b32 m0, 45056
  s_add_u32 s71, s70, 122880
  buffer_load_dwordx4 v46, s[44:47], s71 offen nt lds
  s_mov_b32 s48, s16
  s_mov_b32 s49, s17
  s_mov_b32 s50, 4096
  s_mov_b32 s51, 0x20000
  v_lshl_add_u32 v48, v36, 4, v37
  v_lshlrev_b32 v48, 1, v48
  s_lshl_b32 s70, s62, 7
  s_add_u32 s71, s70, 0
  buffer_load_ushort v224, v48, s[48:51], s71 offen
  s_add_u32 s71, s70, 1024
  buffer_load_ushort v225, v48, s[48:51], s71 offen
  s_add_u32 s71, s70, 2048
  buffer_load_ushort v226, v48, s[48:51], s71 offen
  s_add_u32 s71, s70, 3072
  buffer_load_ushort v227, v48, s[48:51], s71 offen
  s_mov_b32 s90, 0x00ff00ff
  s_mov_b32 s91, 0x00ff00ff
  v_lshrrev_b32 v48, 3, v37
  v_lshl_add_u32 v48, v36, 1, v48
  v_lshlrev_b32 v48, 6, v48
  v_and_b32 v49, 7, v37
  v_lshl_add_u32 v48, v49, 2, v48
  v_lshlrev_b32 v49, 7, v36
  v_add_u32 v50, 32, v49
  v_add_u32 v49, 96, v49
  v_cndmask_b32 v97, v48, v49, s[90:91]
  v_cndmask_b32 v96, v50, v48, s[90:91]
  v_lshl_add_u32 v99, v36, 4, v37
  s_lshl_b32 s70, s62, 6
  v_add_u32 v99, s70, v99
  v_lshlrev_b32 v99, 1, v99
  s_lshl_b32 s99, s62, 9
  s_add_u32 s99, s99, 8192
  v_lshrrev_b32 v121, 3, v37
  v_lshl_add_u32 v121, v36, 1, v121
  v_lshlrev_b32 v121, 4, v121
  v_bfe_u32 v48, v37, 2, 1
  v_lshl_add_u32 v121, v48, 10, v121
  v_bfe_u32 v48, v37, 1, 1
  v_lshl_add_u32 v121, v48, 3, v121
  s_lshl_b32 s100, s62, 7
  s_add_u32 s100, s100, 2424832
  v_and_b32 v46, 3, v37
  v_mul_u32_u24 v46, 272, v46
  v_lshl_add_u32 v46, v36, 4, v46
  v_mov_b32 v45, 0
  v_mov_b32 v64, 0
  v_mov_b32 v65, 0
  v_mov_b32 v66, 0
  v_mov_b32 v67, 0
  v_mov_b32 v68, 0
  v_mov_b32 v69, 0
  v_mov_b32 v70, 0
  v_mov_b32 v71, 0
  v_mov_b32 v72, 0
  v_mov_b32 v73, 0
  v_mov_b32 v74, 0
  v_mov_b32 v75, 0
  v_mov_b32 v76, 0
  v_mov_b32 v77, 0
  v_mov_b32 v78, 0
  v_mov_b32 v79, 0
  v_lshlrev_b32 v120, 3, v2
  v_lshlrev_b32 v122, 4, v2
  s_lshl_b32 s40, s60, 13
  s_add_u32 s40, s40, 2162688
  s_lshl_b32 s41, s62, 10
  s_add_u32 s41, s41, s40
  v_lshlrev_b32 v47, 2, v2
  v_mov_b32 v45, 0
  v_mov_b32 v128, 0
  v_mov_b32 v129, s81
  v_mov_b32 v130, 0
  v_mov_b32 v131, s81
  v_mov_b32 v132, 0
  v_mov_b32 v133, s81
  v_mov_b32 v134, 0
  v_mov_b32 v135, s81
  v_mov_b32 v136, 0
  v_mov_b32 v137, s81
  v_mov_b32 v138, 0
  v_mov_b32 v139, s81
  v_mov_b32 v140, 0
  v_mov_b32 v141, s81
  v_mov_b32 v142, 0
  v_mov_b32 v143, s81
  v_mov_b32 v144, 0
  v_mov_b32 v145, s81
  v_mov_b32 v146, 0
  v_mov_b32 v147, s81
  v_mov_b32 v148, 0
  v_mov_b32 v149, s81
  v_mov_b32 v150, 0
  v_mov_b32 v151, s81
  v_mov_b32 v152, 0
  v_mov_b32 v153, s81
  v_mov_b32 v154, 0
  v_mov_b32 v155, s81
  v_mov_b32 v156, 0
  v_mov_b32 v157, s81
  v_mov_b32 v158, 0
  v_mov_b32 v159, s81
  s_cmp_eq_u32 s61, 0
  s_cselect_b32 s74, 1.0, 0
  s_cmp_eq_u32 s61, 1
  s_cselect_b32 s75, 1.0, 0
  s_cmp_eq_u32 s61, 2
  s_cselect_b32 s76, 1.0, 0
  s_cmp_eq_u32 s61, 3
  s_cselect_b32 s77, 1.0, 0
  v_mov_b32 v124, s74
  v_mov_b32 v125, s75
  v_mov_b32 v126, s76
  v_mov_b32 v127, s77
  s_mov_b32 s86, 0
L_op_15:
  ds_read_b128 v[20:23], v45 offset:29248
  s_waitcnt lgkmcnt(0)
  v_and_b32 v20, v20, v21
  v_and_b32 v22, v22, v23
  v_and_b32 v20, v20, v22
  v_cmp_ne_u32 vcc, 1, v20
  s_nop 0
  s_cmp_eq_u64 vcc, 0
  s_cbranch_scc1 L_opk_16
  s_add_u32 s86, s86, 1
  s_cmp_gt_u32 s86, 0x40000
  s_cbranch_scc1 L_opk_16
  s_sleep 1
  s_branch L_op_15
L_opk_16:
  ds_read_b64 v[20:21], v120 offset:0
  ds_read_b64 v[22:23], v120 offset:512
  ds_read_b64 v[24:25], v120 offset:1024
  ds_read_b64 v[26:27], v120 offset:1536
  s_waitcnt lgkmcnt(0)
  v_add_f32 v20, v20, v22
  v_add_f32 v24, v24, v26
  v_add_f32 v21, v21, v23
  v_add_f32 v25, v25, v27
  v_add_f32 v28, v20, v24
  v_add_f32 v30, v21, v25
  v_mov_b32 v29, s81
  v_mov_b32 v31, s81
  s_add_u32 s42, s41, 524288
  buffer_store_dwordx4 v[28:31], v122, s[52:55], s42 offen
  s_mov_b32 s87, s41
  s_mov_b32 s43, 0xff
  s_bitset0_b32 s43, s62
  v_mov_b32 v116, 0
  v_mov_b32 v117, 0
  v_mov_b32 v118, 0
  v_mov_b32 v119, 0
  s_mov_b32 s74, 0
  s_mov_b32 s75, 0
  s_mov_b32 s76, 0
  s_mov_b32 s77, 0
  s_add_u32 s41, s40, 524288
  s_add_u32 s42, s40, 528384
  s_mov_b32 s86, 0
L_og_20:
  s_bitcmp1_b32 s43, 0
  s_cbranch_scc0 L_ogs_21
  buffer_load_dwordx4 v[128:131], v122, s[52:55], s41 offen offset:0 nt
L_ogs_21:
  s_bitcmp1_b32 s43, 1
  s_cbranch_scc0 L_ogs_22
  buffer_load_dwordx4 v[132:135], v122, s[52:55], s41 offen offset:1024 nt
L_ogs_22:
  s_bitcmp1_b32 s43, 2
  s_cbranch_scc0 L_ogs_23
  buffer_load_dwordx4 v[136:139], v122, s[52:55], s41 offen offset:2048 nt
L_ogs_23:
  s_bitcmp1_b32 s43, 3
  s_cbranch_scc0 L_ogs_24
  buffer_load_dwordx4 v[140:143], v122, s[52:55], s41 offen offset:3072 nt
L_ogs_24:
  s_bitcmp1_b32 s43, 4
  s_cbranch_scc0 L_ogs_25
  buffer_load_dwordx4 v[144:147], v122, s[52:55], s42 offen offset:0 nt
L_ogs_25:
  s_bitcmp1_b32 s43, 5
  s_cbranch_scc0 L_ogs_26
  buffer_load_dwordx4 v[148:151], v122, s[52:55], s42 offen offset:1024 nt
L_ogs_26:
  s_bitcmp1_b32 s43, 6
  s_cbranch_scc0 L_ogs_27
  buffer_load_dwordx4 v[152:155], v122, s[52:55], s42 offen offset:2048 nt
L_ogs_27:
  s_bitcmp1_b32 s43, 7
  s_cbranch_scc0 L_ogs_28
  buffer_load_dwordx4 v[156:159], v122, s[52:55], s42 offen offset:3072 nt
L_ogs_28:
  s_cmp_lg_u32 s86, 0
  s_cbranch_scc1 L_ogf_29
  s_waitcnt vmcnt(8)
  v_lshrrev_b32 v51, 2, v37
  v_lshl_add_u32 v51, v36, 3, v51
  v_lshlrev_b32 v51, 7, v51
  v_and_b32 v48, 3, v37
  v_lshl_add_u32 v51, v48, 3, v51
  ds_read_b64_tr_b16 v[160:161], v51 offset:29696
  ds_read_b64_tr_b16 v[162:163], v51 offset:30208
  ds_read_b64_tr_b16 v[164:165], v51 offset:29728
  ds_read_b64_tr_b16 v[166:167], v51 offset:30240
  ds_read_b64_tr_b16 v[168:169], v51 offset:29760
  ds_read_b64_tr_b16 v[170:171], v51 offset:30272
  ds_read_b64_tr_b16 v[172:173], v51 offset:29792
  ds_read_b64_tr_b16 v[174:175], v51 offset:30304
  ds_read_b64_tr_b16 v[176:177], v51 offset:33792
  ds_read_b64_tr_b16 v[178:179], v51 offset:34304
  ds_read_b64_tr_b16 v[180:181], v51 offset:33824
  ds_read_b64_tr_b16 v[182:183], v51 offset:34336
  ds_read_b64_tr_b16 v[184:185], v51 offset:33856
  ds_read_b64_tr_b16 v[186:187], v51 offset:34368
  ds_read_b64_tr_b16 v[188:189], v51 offset:33888
  ds_read_b64_tr_b16 v[190:191], v51 offset:34400
  ds_read_b64_tr_b16 v[192:193], v51 offset:37888
  ds_read_b64_tr_b16 v[194:195], v51 offset:38400
  ds_read_b64_tr_b16 v[196:197], v51 offset:37920
  ds_read_b64_tr_b16 v[198:199], v51 offset:38432
  ds_read_b64_tr_b16 v[200:201], v51 offset:37952
  ds_read_b64_tr_b16 v[202:203], v51 offset:38464
  ds_read_b64_tr_b16 v[204:205], v51 offset:37984
  ds_read_b64_tr_b16 v[206:207], v51 offset:38496
  ds_read_b64_tr_b16 v[208:209], v51 offset:41984
  ds_read_b64_tr_b16 v[210:211], v51 offset:42496
  ds_read_b64_tr_b16 v[212:213], v51 offset:42016
  ds_read_b64_tr_b16 v[214:215], v51 offset:42528
  ds_read_b64_tr_b16 v[216:217], v51 offset:42048
  ds_read_b64_tr_b16 v[218:219], v51 offset:42560
  ds_read_b64_tr_b16 v[220:221], v51 offset:42080
  ds_read_b64_tr_b16 v[222:223], v51 offset:42592
  v_lshlrev_b32 v224, 16, v224
  v_lshlrev_b32 v225, 16, v225
  v_lshlrev_b32 v226, 16, v226
  v_lshlrev_b32 v227, 16, v227
L_ogf_29:
  s_waitcnt vmcnt(0)
  v_xor_b32 v61, s81, v129
  v_bitop3_b32 v61, v61, v131, s81 bitop3:0xf6
  v_bitop3_b32 v61, v61, v133, s81 bitop3:0xf6
  v_bitop3_b32 v61, v61, v135, s81 bitop3:0xf6
  v_bitop3_b32 v61, v61, v137, s81 bitop3:0xf6
  v_bitop3_b32 v61, v61, v139, s81 bitop3:0xf6
  v_bitop3_b32 v61, v61, v141, s81 bitop3:0xf6
  v_bitop3_b32 v61, v61, v143, s81 bitop3:0xf6
  v_bitop3_b32 v61, v61, v145, s81 bitop3:0xf6
  v_bitop3_b32 v61, v61, v147, s81 bitop3:0xf6
  v_bitop3_b32 v61, v61, v149, s81 bitop3:0xf6
  v_bitop3_b32 v61, v61, v151, s81 bitop3:0xf6
  v_bitop3_b32 v61, v61, v153, s81 bitop3:0xf6
  v_bitop3_b32 v61, v61, v155, s81 bitop3:0xf6
  v_bitop3_b32 v61, v61, v157, s81 bitop3:0xf6
  v_bitop3_b32 v61, v61, v159, s81 bitop3:0xf6
  v_cmp_ne_u32 vcc, 0, v61
  s_nop 0
  s_cmp_eq_u64 vcc, 0
  s_cbranch_scc1 L_ogl_18
  s_bitcmp1_b32 s43, 0
  s_cbranch_scc0 L_ogc_30
  v_xor_b32 v61, s81, v129
  v_bitop3_b32 v61, v61, v131, s81 bitop3:0xf6
  v_cmp_ne_u32 vcc, 0, v61
  s_nop 0
  s_cmp_eq_u64 vcc, 0
  s_cbranch_scc0 L_ogc_30
  s_bitset0_b32 s43, 0
L_ogc_30:
  s_bitcmp1_b32 s43, 1
  s_cbranch_scc0 L_ogc_31
  v_xor_b32 v61, s81, v133
  v_bitop3_b32 v61, v61, v135, s81 bitop3:0xf6
  v_cmp_ne_u32 vcc, 0, v61
  s_nop 0
  s_cmp_eq_u64 vcc, 0
  s_cbranch_scc0 L_ogc_31
  s_bitset0_b32 s43, 1
L_ogc_31:
  s_bitcmp1_b32 s43, 2
  s_cbranch_scc0 L_ogc_32
  v_xor_b32 v61, s81, v137
  v_bitop3_b32 v61, v61, v139, s81 bitop3:0xf6
  v_cmp_ne_u32 vcc, 0, v61
  s_nop 0
  s_cmp_eq_u64 vcc, 0
  s_cbranch_scc0 L_ogc_32
  s_bitset0_b32 s43, 2
L_ogc_32:
  s_bitcmp1_b32 s43, 3
  s_cbranch_scc0 L_ogc_33
  v_xor_b32 v61, s81, v141
  v_bitop3_b32 v61, v61, v143, s81 bitop3:0xf6
  v_cmp_ne_u32 vcc, 0, v61
  s_nop 0
  s_cmp_eq_u64 vcc, 0
  s_cbranch_scc0 L_ogc_33
  s_bitset0_b32 s43, 3
L_ogc_33:
  s_bitcmp1_b32 s43, 4
  s_cbranch_scc0 L_ogc_34
  v_xor_b32 v61, s81, v145
  v_bitop3_b32 v61, v61, v147, s81 bitop3:0xf6
  v_cmp_ne_u32 vcc, 0, v61
  s_nop 0
  s_cmp_eq_u64 vcc, 0
  s_cbranch_scc0 L_ogc_34
  s_bitset0_b32 s43, 4
L_ogc_34:
  s_bitcmp1_b32 s43, 5
  s_cbranch_scc0 L_ogc_35
  v_xor_b32 v61, s81, v149
  v_bitop3_b32 v61, v61, v151, s81 bitop3:0xf6
  v_cmp_ne_u32 vcc, 0, v61
  s_nop 0
  s_cmp_eq_u64 vcc, 0
  s_cbranch_scc0 L_ogc_35
  s_bitset0_b32 s43, 5
L_ogc_35:
  s_bitcmp1_b32 s43, 6
  s_cbranch_scc0 L_ogc_36
  v_xor_b32 v61, s81, v153
  v_bitop3_b32 v61, v61, v155, s81 bitop3:0xf6
  v_cmp_ne_u32 vcc, 0, v61
  s_nop 0
  s_cmp_eq_u64 vcc, 0
  s_cbranch_scc0 L_ogc_36
  s_bitset0_b32 s43, 6
L_ogc_36:
  s_bitcmp1_b32 s43, 7
  s_cbranch_scc0 L_ogc_37
  v_xor_b32 v61, s81, v157
  v_bitop3_b32 v61, v61, v159, s81 bitop3:0xf6
  v_cmp_ne_u32 vcc, 0, v61
  s_nop 0
  s_cmp_eq_u64 vcc, 0
  s_cbranch_scc0 L_ogc_37
  s_bitset0_b32 s43, 7
L_ogc_37:
  s_cmp_eq_u32 s43, 0
  s_cbranch_scc1 L_ogl_18
  s_bcnt1_i32_b32 s70, s43
  s_cmp_lg_u32 s70, 1
  s_cbranch_scc1 L_ogn_38
  s_ff1_i32_b32 s70, s43
  s_lshl_b32 s71, s70, 10
  s_add_u32 s71, s71, s41
  buffer_load_dwordx4 v[116:119], v122, s[52:55], s71 offen nt
  s_cmp_lg_u32 s70, 0
  s_cbranch_scc1 L_ogz_41
  v_mov_b32 v128, 0
  v_mov_b32 v130, 0
  s_mov_b32 s74, 1.0
  s_branch L_ogd_40
L_ogz_41:
  s_cmp_lg_u32 s70, 1
  s_cbranch_scc1 L_ogz_42
  v_mov_b32 v132, 0
  v_mov_b32 v134, 0
  s_mov_b32 s74, 1.0
  s_branch L_ogd_40
L_ogz_42:
  s_cmp_lg_u32 s70, 2
  s_cbranch_scc1 L_ogz_43
  v_mov_b32 v136, 0
  v_mov_b32 v138, 0
  s_mov_b32 s75, 1.0
  s_branch L_ogd_40
L_ogz_43:
  s_cmp_lg_u32 s70, 3
  s_cbranch_scc1 L_ogz_44
  v_mov_b32 v140, 0
  v_mov_b32 v142, 0
  s_mov_b32 s75, 1.0
  s_branch L_ogd_40
L_ogz_44:
  s_cmp_lg_u32 s70, 4
  s_cbranch_scc1 L_ogz_45
  v_mov_b32 v144, 0
  v_mov_b32 v146, 0
  s_mov_b32 s76, 1.0
  s_branch L_ogd_40
L_ogz_45:
  s_cmp_lg_u32 s70, 5
  s_cbranch_scc1 L_ogz_46
  v_mov_b32 v148, 0
  v_mov_b32 v150, 0
  s_mov_b32 s76, 1.0
  s_branch L_ogd_40
L_ogz_46:
  s_cmp_lg_u32 s70, 6
  s_cbranch_scc1 L_ogz_47
  v_mov_b32 v152, 0
  v_mov_b32 v154, 0
  s_mov_b32 s77, 1.0
  s_branch L_ogd_40
L_ogz_47:
  s_cmp_lg_u32 s70, 7
  s_cbranch_scc1 L_ogz_48
  v_mov_b32 v156, 0
  v_mov_b32 v158, 0
  s_mov_b32 s77, 1.0
  s_branch L_ogd_40
L_ogz_48:
L_ogd_40:
  s_waitcnt vmcnt(0)
  v_xor_b32 v61, s81, v117
  v_bitop3_b32 v61, v61, v119, s81 bitop3:0xf6
  v_cmp_ne_u32 vcc, 0, v61
  s_nop 0
  s_cmp_eq_u64 vcc, 0
  s_cbranch_scc1 L_ogl_18
L_ogt_39:
  buffer_load_dwordx4 v[116:119], v122, s[52:55], s71 offen nt
  s_add_u32 s86, s86, 1
  s_cmp_gt_u32 s86, 64
  s_cselect_b32 s72, 1, 0
  s_waitcnt vmcnt(0)
  v_xor_b32 v61, s81, v117
  v_bitop3_b32 v61, v61, v119, s81 bitop3:0xf6
  v_cmp_ne_u32 vcc, 0, v61
  s_nop 0
  s_cmp_eq_u64 vcc, 0
  s_cbranch_scc1 L_ogl_18
  s_cmp_eq_u32 s72, 0
  s_cbranch_scc1 L_ogt_39
  v_mov_b32 v116, 0
  v_mov_b32 v117, 0
  v_mov_b32 v118, 0
  v_mov_b32 v119, 0
  s_mov_b32 s74, 0
  s_mov_b32 s75, 0
  s_mov_b32 s76, 0
  s_mov_b32 s77, 0
  s_branch L_ogfb_19
L_ogn_38:
  s_add_u32 s86, s86, 1
  s_cmp_le_u32 s86, 64
  s_cbranch_scc1 L_og_20
L_ogfb_19:
  buffer_store_dwordx4 v[28:31], v122, s[52:55], s87 offen sc1
  s_add_u32 s41, s40, 0
  s_add_u32 s42, s40, 4096
  s_mov_b32 s86, 0
L_og_49:
  s_bitcmp1_b32 s43, 0
  s_cbranch_scc0 L_ogs_50
  buffer_load_dwordx4 v[128:131], v122, s[52:55], s41 offen offset:0 sc1
L_ogs_50:
  s_bitcmp1_b32 s43, 1
  s_cbranch_scc0 L_ogs_51
  buffer_load_dwordx4 v[132:135], v122, s[52:55], s41 offen offset:1024 sc1
L_ogs_51:
  s_bitcmp1_b32 s43, 2
  s_cbranch_scc0 L_ogs_52
  buffer_load_dwordx4 v[136:139], v122, s[52:55], s41 offen offset:2048 sc1
L_ogs_52:
  s_bitcmp1_b32 s43, 3
  s_cbranch_scc0 L_ogs_53
  buffer_load_dwordx4 v[140:143], v122, s[52:55], s41 offen offset:3072 sc1
L_ogs_53:
  s_bitcmp1_b32 s43, 4
  s_cbranch_scc0 L_ogs_54
  buffer_load_dwordx4 v[144:147], v122, s[52:55], s42 offen offset:0 sc1
L_ogs_54:
  s_bitcmp1_b32 s43, 5
  s_cbranch_scc0 L_ogs_55
  buffer_load_dwordx4 v[148:151], v122, s[52:55], s42 offen offset:1024 sc1
L_ogs_55:
  s_bitcmp1_b32 s43, 6
  s_cbranch_scc0 L_ogs_56
  buffer_load_dwordx4 v[152:155], v122, s[52:55], s42 offen offset:2048 sc1
L_ogs_56:
  s_bitcmp1_b32 s43, 7
  s_cbranch_scc0 L_ogs_57
  buffer_load_dwordx4 v[156:159], v122, s[52:55], s42 offen offset:3072 sc1
L_ogs_57:
  s_waitcnt vmcnt(0)
  v_xor_b32 v61, s81, v129
  v_bitop3_b32 v61, v61, v131, s81 bitop3:0xf6
  v_bitop3_b32 v61, v61, v133, s81 bitop3:0xf6
  v_bitop3_b32 v61, v61, v135, s81 bitop3:0xf6
  v_bitop3_b32 v61, v61, v137, s81 bitop3:0xf6
  v_bitop3_b32 v61, v61, v139, s81 bitop3:0xf6
  v_bitop3_b32 v61, v61, v141, s81 bitop3:0xf6
  v_bitop3_b32 v61, v61, v143, s81 bitop3:0xf6
  v_bitop3_b32 v61, v61, v145, s81 bitop3:0xf6
  v_bitop3_b32 v61, v61, v147, s81 bitop3:0xf6
  v_bitop3_b32 v61, v61, v149, s81 bitop3:0xf6
  v_bitop3_b32 v61, v61, v151, s81 bitop3:0xf6
  v_bitop3_b32 v61, v61, v153, s81 bitop3:0xf6
  v_bitop3_b32 v61, v61, v155, s81 bitop3:0xf6
  v_bitop3_b32 v61, v61, v157, s81 bitop3:0xf6
  v_bitop3_b32 v61, v61, v159, s81 bitop3:0xf6
  v_cmp_ne_u32 vcc, 0, v61
  s_nop 0
  s_cmp_eq_u64 vcc, 0
  s_cbranch_scc1 L_ogk_17
  s_bitcmp1_b32 s43, 0
  s_cbranch_scc0 L_ogc_58
  v_xor_b32 v61, s81, v129
  v_bitop3_b32 v61, v61, v131, s81 bitop3:0xf6
  v_cmp_ne_u32 vcc, 0, v61
  s_nop 0
  s_cmp_eq_u64 vcc, 0
  s_cbranch_scc0 L_ogc_58
  s_bitset0_b32 s43, 0
L_ogc_58:
  s_bitcmp1_b32 s43, 1
  s_cbranch_scc0 L_ogc_59
  v_xor_b32 v61, s81, v133
  v_bitop3_b32 v61, v61, v135, s81 bitop3:0xf6
  v_cmp_ne_u32 vcc, 0, v61
  s_nop 0
  s_cmp_eq_u64 vcc, 0
  s_cbranch_scc0 L_ogc_59
  s_bitset0_b32 s43, 1
L_ogc_59:
  s_bitcmp1_b32 s43, 2
  s_cbranch_scc0 L_ogc_60
  v_xor_b32 v61, s81, v137
  v_bitop3_b32 v61, v61, v139, s81 bitop3:0xf6
  v_cmp_ne_u32 vcc, 0, v61
  s_nop 0
  s_cmp_eq_u64 vcc, 0
  s_cbranch_scc0 L_ogc_60
  s_bitset0_b32 s43, 2
L_ogc_60:
  s_bitcmp1_b32 s43, 3
  s_cbranch_scc0 L_ogc_61
  v_xor_b32 v61, s81, v141
  v_bitop3_b32 v61, v61, v143, s81 bitop3:0xf6
  v_cmp_ne_u32 vcc, 0, v61
  s_nop 0
  s_cmp_eq_u64 vcc, 0
  s_cbranch_scc0 L_ogc_61
  s_bitset0_b32 s43, 3
L_ogc_61:
  s_bitcmp1_b32 s43, 4
  s_cbranch_scc0 L_ogc_62
  v_xor_b32 v61, s81, v145
  v_bitop3_b32 v61, v61, v147, s81 bitop3:0xf6
  v_cmp_ne_u32 vcc, 0, v61
  s_nop 0
  s_cmp_eq_u64 vcc, 0
  s_cbranch_scc0 L_ogc_62
  s_bitset0_b32 s43, 4
L_ogc_62:
  s_bitcmp1_b32 s43, 5
  s_cbranch_scc0 L_ogc_63
  v_xor_b32 v61, s81, v149
  v_bitop3_b32 v61, v61, v151, s81 bitop3:0xf6
  v_cmp_ne_u32 vcc, 0, v61
  s_nop 0
  s_cmp_eq_u64 vcc, 0
  s_cbranch_scc0 L_ogc_63
  s_bitset0_b32 s43, 5
L_ogc_63:
  s_bitcmp1_b32 s43, 6
  s_cbranch_scc0 L_ogc_64
  v_xor_b32 v61, s81, v153
  v_bitop3_b32 v61, v61, v155, s81 bitop3:0xf6
  v_cmp_ne_u32 vcc, 0, v61
  s_nop 0
  s_cmp_eq_u64 vcc, 0
  s_cbranch_scc0 L_ogc_64
  s_bitset0_b32 s43, 6
L_ogc_64:
  s_bitcmp1_b32 s43, 7
  s_cbranch_scc0 L_ogc_65
  v_xor_b32 v61, s81, v157
  v_bitop3_b32 v61, v61, v159, s81 bitop3:0xf6
  v_cmp_ne_u32 vcc, 0, v61
  s_nop 0
  s_cmp_eq_u64 vcc, 0
  s_cbranch_scc0 L_ogc_65
  s_bitset0_b32 s43, 7
L_ogc_65:
  s_cmp_eq_u32 s43, 0
  s_cbranch_scc1 L_ogk_17
  s_add_u32 s86, s86, 1
  s_cmp_le_u32 s86, 131072
  s_cbranch_scc1 L_og_49
  s_branch L_ogk_17
L_ogl_18:
  s_mov_b32 s43, 1
  s_branch L_ogp_66
L_ogk_17:
  s_mov_b32 s43, 0
L_ogp_66:
  v_add_f32 v128, v128, v132
  v_add_f32 v130, v130, v134
  v_fma_f32 v128, v28, v124, v128
  v_fma_f32 v130, v30, v124, v130
  v_fma_f32 v128, v116, s74, v128
  v_fma_f32 v130, v118, s74, v130
  v_cvt_pk_bf16_f32 v128, v128, v130
  ds_write_b32 v47, v128 offset:25024
  v_add_f32 v136, v136, v140
  v_add_f32 v138, v138, v142
  v_fma_f32 v136, v28, v125, v136
  v_fma_f32 v138, v30, v125, v138
  v_fma_f32 v136, v116, s75, v136
  v_fma_f32 v138, v118, s75, v138
  v_cvt_pk_bf16_f32 v136, v136, v138
  ds_write_b32 v47, v136 offset:25296
  v_add_f32 v144, v144, v148
  v_add_f32 v146, v146, v150
  v_fma_f32 v144, v28, v126, v144
  v_fma_f32 v146, v30, v126, v146
  v_fma_f32 v144, v116, s76, v144
  v_fma_f32 v146, v118, s76, v146
  v_cvt_pk_bf16_f32 v144, v144, v146
  ds_write_b32 v47, v144 offset:25568
  v_add_f32 v152, v152, v156
  v_add_f32 v154, v154, v158
  v_fma_f32 v152, v28, v127, v152
  v_fma_f32 v154, v30, v127, v154
  v_fma_f32 v152, v116, s77, v152
  v_fma_f32 v154, v118, s77, v154
  v_cvt_pk_bf16_f32 v152, v152, v154
  ds_write_b32 v47, v152 offset:25840
  s_waitcnt lgkmcnt(0)
  v_mov_b32 v48, 1
  ds_write_b32 v45, v48 offset:29268
  ds_read_b128 v[104:107], v46 offset:25024
  ds_read_b128 v[108:111], v46 offset:25088
  ds_read_b128 v[112:115], v46 offset:25152
  ds_read_b128 v[116:119], v46 offset:25216
  s_waitcnt lgkmcnt(3)
  v_mfma_f32_16x16x32_bf16 v[64:67], v[104:107], v[160:163], v[64:67]
  v_mfma_f32_16x16x32_bf16 v[68:71], v[104:107], v[164:167], v[68:71]
  v_mfma_f32_16x16x32_bf16 v[72:75], v[104:107], v[168:171], v[72:75]
  v_mfma_f32_16x16x32_bf16 v[76:79], v[104:107], v[172:175], v[76:79]
  s_waitcnt lgkmcnt(2)
  v_mfma_f32_16x16x32_bf16 v[64:67], v[108:111], v[176:179], v[64:67]
  v_mfma_f32_16x16x32_bf16 v[68:71], v[108:111], v[180:183], v[68:71]
  v_mfma_f32_16x16x32_bf16 v[72:75], v[108:111], v[184:187], v[72:75]
  v_mfma_f32_16x16x32_bf16 v[76:79], v[108:111], v[188:191], v[76:79]
  s_waitcnt lgkmcnt(1)
  v_mfma_f32_16x16x32_bf16 v[64:67], v[112:115], v[192:195], v[64:67]
  v_mfma_f32_16x16x32_bf16 v[68:71], v[112:115], v[196:199], v[68:71]
  v_mfma_f32_16x16x32_bf16 v[72:75], v[112:115], v[200:203], v[72:75]
  v_mfma_f32_16x16x32_bf16 v[76:79], v[112:115], v[204:207], v[76:79]
  s_waitcnt lgkmcnt(0)
  v_mfma_f32_16x16x32_bf16 v[64:67], v[116:119], v[208:211], v[64:67]
  v_mfma_f32_16x16x32_bf16 v[68:71], v[116:119], v[212:215], v[68:71]
  v_mfma_f32_16x16x32_bf16 v[72:75], v[116:119], v[216:219], v[72:75]
  v_mfma_f32_16x16x32_bf16 v[76:79], v[116:119], v[220:223], v[76:79]
  s_add_u32 s70, s99, 0
  s_add_u32 s71, s99, 4096
  s_add_u32 s72, s99, 8192
  s_add_u32 s73, s99, 12288
  s_mov_b32 s98, 0x41f80000
  s_nop 0
  v_mov_b32_dpp v64, v68 quad_perm:[0,1,2,3] row_mask:0x2 bank_mask:0xf
  v_mov_b32_dpp v65, v69 quad_perm:[0,1,2,3] row_mask:0x2 bank_mask:0xf
  v_mov_b32_dpp v66, v70 quad_perm:[0,1,2,3] row_mask:0x2 bank_mask:0xf
  v_mov_b32_dpp v67, v71 quad_perm:[0,1,2,3] row_mask:0x2 bank_mask:0xf
  v_mov_b32_dpp v64, v72 quad_perm:[0,1,2,3] row_mask:0x4 bank_mask:0xf
  v_mov_b32_dpp v65, v73 quad_perm:[0,1,2,3] row_mask:0x4 bank_mask:0xf
  v_mov_b32_dpp v66, v74 quad_perm:[0,1,2,3] row_mask:0x4 bank_mask:0xf
  v_mov_b32_dpp v67, v75 quad_perm:[0,1,2,3] row_mask:0x4 bank_mask:0xf
  v_mov_b32_dpp v64, v76 quad_perm:[0,1,2,3] row_mask:0x8 bank_mask:0xf
  v_mov_b32_dpp v65, v77 quad_perm:[0,1,2,3] row_mask:0x8 bank_mask:0xf
  v_mov_b32_dpp v66, v78 quad_perm:[0,1,2,3] row_mask:0x8 bank_mask:0xf
  v_mov_b32_dpp v67, v79 quad_perm:[0,1,2,3] row_mask:0x8 bank_mask:0xf
  v_cndmask_b32 v84, 1.0, v64, s[90:91]
  v_cndmask_b32 v86, 1.0, v65, s[90:91]
  v_cndmask_b32 v88, 1.0, v66, s[90:91]
  v_cndmask_b32 v90, 1.0, v67, s[90:91]
  s_mov_b32 exec_lo, 0x01ff01ff
  s_mov_b32 exec_hi, 0x01ff01ff
  buffer_atomic_add_f32 v84, v96, s[52:55], s70 offen sc0
  buffer_atomic_add_f32 v86, v96, s[52:55], s71 offen sc0
  buffer_atomic_add_f32 v88, v96, s[52:55], s72 offen sc0
  buffer_atomic_add_f32 v90, v96, s[52:55], s73 offen sc0
  s_mov_b64 exec, -1
  v_mov_b32 v85, 1.0
  v_cndmask_b32 v85, v64, v85, s[90:91]
  v_mov_b32 v87, 1.0
  v_cndmask_b32 v87, v65, v87, s[90:91]
  v_mov_b32 v89, 1.0
  v_cndmask_b32 v89, v66, v89, s[90:91]
  v_mov_b32 v91, 1.0
  v_cndmask_b32 v91, v67, v91, s[90:91]
  s_mov_b32 exec_lo, 0xff80ff80
  s_mov_b32 exec_hi, 0xff80ff80
  buffer_atomic_add_f32 v85, v97, s[52:55], s70 offen sc0
  buffer_atomic_add_f32 v87, v97, s[52:55], s71 offen sc0
  buffer_atomic_add_f32 v89, v97, s[52:55], s72 offen sc0
  buffer_atomic_add_f32 v91, v97, s[52:55], s73 offen sc0
  s_mov_b64 exec, -1
  s_waitcnt vmcnt(0)
  v_mov_b32_dpp v100, v84 row_newbcast:8 row_mask:0xf bank_mask:0x3
  v_mov_b32_dpp v100, v85 row_newbcast:7 row_mask:0xf bank_mask:0xc
  v_mov_b32_dpp v101, v86 row_newbcast:8 row_mask:0xf bank_mask:0x3
  v_mov_b32_dpp v101, v87 row_newbcast:7 row_mask:0xf bank_mask:0xc
  v_mov_b32_dpp v102, v88 row_newbcast:8 row_mask:0xf bank_mask:0x3
  v_mov_b32_dpp v102, v89 row_newbcast:7 row_mask:0xf bank_mask:0xc
  v_mov_b32_dpp v103, v90 row_newbcast:8 row_mask:0xf bank_mask:0x3
  v_mov_b32_dpp v103, v91 row_newbcast:7 row_mask:0xf bank_mask:0xc
  v_cndmask_b32 v84, v85, v84, s[90:91]
  v_add_f32 v64, v64, v84
  v_cvt_pk_bf16_f32 v64, v64, v64
  v_lshlrev_b32 v64, 16, v64
  v_cndmask_b32 v86, v87, v86, s[90:91]
  v_add_f32 v65, v65, v86
  v_cvt_pk_bf16_f32 v65, v65, v65
  v_lshlrev_b32 v65, 16, v65
  v_cndmask_b32 v88, v89, v88, s[90:91]
  v_add_f32 v66, v66, v88
  v_cvt_pk_bf16_f32 v66, v66, v66
  v_lshlrev_b32 v66, 16, v66
  v_cndmask_b32 v90, v91, v90, s[90:91]
  v_add_f32 v67, v67, v90
  v_cvt_pk_bf16_f32 v67, v67, v67
  v_lshlrev_b32 v67, 16, v67
  v_add_f32 v64, v64, v224
  s_nop 1
  v_mov_b32_dpp v68, v64 quad_perm:[1,0,3,2] row_mask:0xf bank_mask:0xf
  v_cvt_pk_bf16_f32 v68, v64, v68
  v_mov_b32 v69, s81
  v_add_f32 v65, v65, v225
  s_nop 1
  v_mov_b32_dpp v70, v65 quad_perm:[1,0,3,2] row_mask:0xf bank_mask:0xf
  v_cvt_pk_bf16_f32 v70, v65, v70
  v_mov_b32 v71, s81
  v_add_f32 v66, v66, v226
  s_nop 1
  v_mov_b32_dpp v72, v66 quad_perm:[1,0,3,2] row_mask:0xf bank_mask:0xf
  v_cvt_pk_bf16_f32 v72, v66, v72
  v_mov_b32 v73, s81
  v_add_f32 v67, v67, v227
  s_nop 1
  v_mov_b32_dpp v74, v67 quad_perm:[1,0,3,2] row_mask:0xf bank_mask:0xf
  v_cvt_pk_bf16_f32 v74, v67, v74
  v_mov_b32 v75, s81
  v_cmp_eq_u32 vcc, s98, v100
  s_nop 0
  s_and_b32 vcc_lo, vcc_lo, 0x55555555
  s_and_b32 vcc_hi, vcc_hi, 0x55555555
  s_cmp_eq_u64 vcc, 0
  s_cbranch_scc1 L_nh_67
  s_mov_b64 exec, vcc
  s_add_u32 s70, s100, 0
  buffer_store_dwordx2 v[68:69], v121, s[52:55], s70 offen sc1
  s_mov_b64 exec, -1
L_nh_67:
  v_cmp_eq_u32 vcc, s98, v101
  s_nop 0
  s_and_b32 vcc_lo, vcc_lo, 0x55555555
  s_and_b32 vcc_hi, vcc_hi, 0x55555555
  s_cmp_eq_u64 vcc, 0
  s_cbranch_scc1 L_nh_68
  s_mov_b64 exec, vcc
  s_add_u32 s70, s100, 2048
  buffer_store_dwordx2 v[70:71], v121, s[52:55], s70 offen sc1
  s_mov_b64 exec, -1
L_nh_68:
  v_cmp_eq_u32 vcc, s98, v102
  s_nop 0
  s_and_b32 vcc_lo, vcc_lo, 0x55555555
  s_and_b32 vcc_hi, vcc_hi, 0x55555555
  s_cmp_eq_u64 vcc, 0
  s_cbranch_scc1 L_nh_69
  s_mov_b64 exec, vcc
  s_add_u32 s70, s100, 4096
  buffer_store_dwordx2 v[72:73], v121, s[52:55], s70 offen sc1
  s_mov_b64 exec, -1
L_nh_69:
  v_cmp_eq_u32 vcc, s98, v103
  s_nop 0
  s_and_b32 vcc_lo, vcc_lo, 0x55555555
  s_and_b32 vcc_hi, vcc_hi, 0x55555555
  s_cmp_eq_u64 vcc, 0
  s_cbranch_scc1 L_nh_70
  s_mov_b64 exec, vcc
  s_add_u32 s70, s100, 6144
  buffer_store_dwordx2 v[74:75], v121, s[52:55], s70 offen sc1
  s_mov_b64 exec, -1
L_nh_70:
  s_cmp_eq_u32 s43, 0
  s_cbranch_scc1 L_lp_71
  buffer_store_dwordx4 v[28:31], v122, s[52:55], s87 offen sc1
L_lp_71:
  s_branch L_H_fin
L_H_rpub:
  v_lshlrev_b32 v120, 3, v2
  v_lshlrev_b32 v122, 4, v2
  s_lshl_b32 s40, s60, 13
  s_add_u32 s40, s40, 2162688
  s_lshl_b32 s41, s62, 10
  s_add_u32 s41, s41, s40
  v_lshlrev_b32 v47, 2, v2
  v_mov_b32 v45, 0
  v_mov_b32 v128, 0
  v_mov_b32 v129, s81
  v_mov_b32 v130, 0
  v_mov_b32 v131, s81
  v_mov_b32 v132, 0
  v_mov_b32 v133, s81
  v_mov_b32 v134, 0
  v_mov_b32 v135, s81
  v_mov_b32 v136, 0
  v_mov_b32 v137, s81
  v_mov_b32 v138, 0
  v_mov_b32 v139, s81
  v_mov_b32 v140, 0
  v_mov_b32 v141, s81
  v_mov_b32 v142, 0
  v_mov_b32 v143, s81
  v_mov_b32 v144, 0
  v_mov_b32 v145, s81
  v_mov_b32 v146, 0
  v_mov_b32 v147, s81
  v_mov_b32 v148, 0
  v_mov_b32 v149, s81
  v_mov_b32 v150, 0
  v_mov_b32 v151, s81
  v_mov_b32 v152, 0
  v_mov_b32 v153, s81
  v_mov_b32 v154, 0
  v_mov_b32 v155, s81
  v_mov_b32 v156, 0
  v_mov_b32 v157, s81
  v_mov_b32 v158, 0
  v_mov_b32 v159, s81
  s_cmp_eq_u32 s61, 0
  s_cselect_b32 s74, 1.0, 0
  s_cmp_eq_u32 s61, 1
  s_cselect_b32 s75, 1.0, 0
  s_cmp_eq_u32 s61, 2
  s_cselect_b32 s76, 1.0, 0
  s_cmp_eq_u32 s61, 3
  s_cselect_b32 s77, 1.0, 0
  v_mov_b32 v124, s74
  v_mov_b32 v125, s75
  v_mov_b32 v126, s76
  v_mov_b32 v127, s77
  s_mov_b32 s86, 0
L_op_72:
  ds_read_b128 v[20:23], v45 offset:29248
  s_waitcnt lgkmcnt(0)
  v_and_b32 v20, v20, v21
  v_and_b32 v22, v22, v23
  v_and_b32 v20, v20, v22
  v_cmp_ne_u32 vcc, 1, v20
  s_nop 0
  s_cmp_eq_u64 vcc, 0
  s_cbranch_scc1 L_opk_73
  s_add_u32 s86, s86, 1
  s_cmp_gt_u32 s86, 0x40000
  s_cbranch_scc1 L_opk_73
  s_sleep 1
  s_branch L_op_72
L_opk_73:
  ds_read_b64 v[20:21], v120 offset:0
  ds_read_b64 v[22:23], v120 offset:512
  ds_read_b64 v[24:25], v120 offset:1024
  ds_read_b64 v[26:27], v120 offset:1536
  s_waitcnt lgkmcnt(0)
  v_add_f32 v20, v20, v22
  v_add_f32 v24, v24, v26
  v_add_f32 v21, v21, v23
  v_add_f32 v25, v25, v27
  v_add_f32 v28, v20, v24
  v_add_f32 v30, v21, v25
  v_mov_b32 v29, s81
  v_mov_b32 v31, s81
  s_add_u32 s42, s41, 524288
  buffer_store_dwordx4 v[28:31], v122, s[52:55], s42 offen
  s_mov_b32 s87, s41
  buffer_store_dwordx4 v[28:31], v122, s[52:55], s41 offen sc1
  v_mov_b32 v48, 1
  ds_write_b32 v45, v48 offset:29264
  s_branch L_H_r2
L_H_sub:
  v_mov_b32 v49, 0
  s_mov_b32 s86, 0
L_wt_74:
  ds_read_b128 v[20:23], v49 offset:29184
  s_waitcnt lgkmcnt(0)
  v_min_u32 v20, v20, v21
  v_min3_u32 v20, v20, v22, v23
  s_nop 0
  v_readfirstlane_b32 s70, v20
  s_nop 0
  s_cmp_ge_u32 s70, 253
  s_cbranch_scc1 L_wtk_75
  s_add_u32 s86, s86, 1
  s_cmp_gt_u32 s86, 0x40000
  s_cbranch_scc1 L_wtk_75
  s_sleep 3
  s_branch L_wt_74
L_wtk_75:
  s_mov_b32 s44, s24
  s_mov_b32 s45, s25
  s_mov_b32 s46, 4194304
  s_mov_b32 s47, 0x20000
  v_lshrrev_b32 v46, 3, v2
  v_lshlrev_b32 v46, 10, v46
  v_and_b32 v47, 7, v2
  v_lshl_add_u32 v46, v47, 4, v46
  s_lshl_b32 s70, s60, 17
  s_lshl_b32 s71, s85, 7
  s_add_u32 s70, s70, s71
  s_mov_b32 m0, 46080
  s_add_u32 s71, s70, 0
  buffer_load_dwordx4 v46, s[44:47], s71 offen nt lds
  s_mov_b32 m0, 47104
  s_add_u32 s71, s70, 8192
  buffer_load_dwordx4 v46, s[44:47], s71 offen nt lds
  s_mov_b32 m0, 48128
  s_add_u32 s71, s70, 16384
  buffer_load_dwordx4 v46, s[44:47], s71 offen nt lds
  s_mov_b32 m0, 49152
  s_add_u32 s71, s70, 24576
  buffer_load_dwordx4 v46, s[44:47], s71 offen nt lds
  s_mov_b32 m0, 50176
  s_add_u32 s71, s70, 32768
  buffer_load_dwordx4 v46, s[44:47], s71 offen nt lds
  s_mov_b32 m0, 51200
  s_add_u32 s71, s70, 40960
  buffer_load_dwordx4 v46, s[44:47], s71 offen nt lds
  s_mov_b32 m0, 52224
  s_add_u32 s71, s70, 49152
  buffer_load_dwordx4 v46, s[44:47], s71 offen nt lds
  s_mov_b32 m0, 53248
  s_add_u32 s71, s70, 57344
  buffer_load_dwordx4 v46, s[44:47], s71 offen nt lds
  s_mov_b32 m0, 54272
  s_add_u32 s71, s70, 65536
  buffer_load_dwordx4 v46, s[44:47], s71 offen nt lds
  s_mov_b32 m0, 55296
  s_add_u32 s71, s70, 73728
  buffer_load_dwordx4 v46, s[44:47], s71 offen nt lds
  s_mov_b32 m0, 56320
  s_add_u32 s71, s70, 81920
  buffer_load_dwordx4 v46, s[44:47], s71 offen nt lds
  s_mov_b32 m0, 57344
  s_add_u32 s71, s70, 90112
  buffer_load_dwordx4 v46, s[44:47], s71 offen nt lds
  s_mov_b32 m0, 58368
  s_add_u32 s71, s70, 98304
  buffer_load_dwordx4 v46, s[44:47], s71 offen nt lds
  s_mov_b32 m0, 59392
  s_add_u32 s71, s70, 106496
  buffer_load_dwordx4 v46, s[44:47], s71 offen nt lds
  s_mov_b32 m0, 60416
  s_add_u32 s71, s70, 114688
  buffer_load_dwordx4 v46, s[44:47], s71 offen nt lds
  s_mov_b32 m0, 61440
  s_add_u32 s71, s70, 122880
  buffer_load_dwordx4 v46, s[44:47], s71 offen nt lds
  s_mov_b32 s48, s16
  s_mov_b32 s49, s17
  s_mov_b32 s50, 4096
  s_mov_b32 s51, 0x20000
  v_lshl_add_u32 v48, v36, 4, v37
  v_lshlrev_b32 v48, 1, v48
  s_lshl_b32 s70, s85, 7
  s_add_u32 s71, s70, 0
  buffer_load_ushort v224, v48, s[48:51], s71 offen
  s_add_u32 s71, s70, 1024
  buffer_load_ushort v225, v48, s[48:51], s71 offen
  s_add_u32 s71, s70, 2048
  buffer_load_ushort v226, v48, s[48:51], s71 offen
  s_add_u32 s71, s70, 3072
  buffer_load_ushort v227, v48, s[48:51], s71 offen
  s_mov_b32 s90, 0x00ff00ff
  s_mov_b32 s91, 0x00ff00ff
  v_lshrrev_b32 v48, 3, v37
  v_lshl_add_u32 v48, v36, 1, v48
  v_lshlrev_b32 v48, 6, v48
  v_and_b32 v49, 7, v37
  v_lshl_add_u32 v48, v49, 2, v48
  v_lshlrev_b32 v49, 7, v36
  v_add_u32 v50, 32, v49
  v_add_u32 v49, 96, v49
  v_cndmask_b32 v97, v48, v49, s[90:91]
  v_cndmask_b32 v96, v50, v48, s[90:91]
  v_lshl_add_u32 v99, v36, 4, v37
  s_lshl_b32 s70, s85, 6
  v_add_u32 v99, s70, v99
  v_lshlrev_b32 v99, 1, v99
  s_lshl_b32 s99, s85, 9
  s_add_u32 s99, s99, 8192
  v_lshrrev_b32 v121, 3, v37
  v_lshl_add_u32 v121, v36, 1, v121
  v_lshlrev_b32 v121, 4, v121
  v_bfe_u32 v48, v37, 2, 1
  v_lshl_add_u32 v121, v48, 10, v121
  v_bfe_u32 v48, v37, 1, 1
  v_lshl_add_u32 v121, v48, 3, v121
  s_lshl_b32 s100, s85, 7
  s_add_u32 s100, s100, 2424832
  v_and_b32 v46, 3, v37
  v_mul_u32_u24 v46, 272, v46
  v_lshl_add_u32 v46, v36, 4, v46
  v_mov_b32 v45, 0
  v_mov_b32 v64, 0
  v_mov_b32 v65, 0
  v_mov_b32 v66, 0
  v_mov_b32 v67, 0
  v_mov_b32 v68, 0
  v_mov_b32 v69, 0
  v_mov_b32 v70, 0
  v_mov_b32 v71, 0
  v_mov_b32 v72, 0
  v_mov_b32 v73, 0
  v_mov_b32 v74, 0
  v_mov_b32 v75, 0
  v_mov_b32 v76, 0
  v_mov_b32 v77, 0
  v_mov_b32 v78, 0
  v_mov_b32 v79, 0
  s_waitcnt vmcnt(0)
  v_lshrrev_b32 v51, 2, v37
  v_lshl_add_u32 v51, v36, 3, v51
  v_lshlrev_b32 v51, 7, v51
  v_and_b32 v48, 3, v37
  v_lshl_add_u32 v51, v48, 3, v51
  ds_read_b64_tr_b16 v[160:161], v51 offset:46080
  ds_read_b64_tr_b16 v[162:163], v51 offset:46592
  ds_read_b64_tr_b16 v[164:165], v51 offset:46112
  ds_read_b64_tr_b16 v[166:167], v51 offset:46624
  ds_read_b64_tr_b16 v[168:169], v51 offset:46144
  ds_read_b64_tr_b16 v[170:171], v51 offset:46656
  ds_read_b64_tr_b16 v[172:173], v51 offset:46176
  ds_read_b64_tr_b16 v[174:175], v51 offset:46688
  ds_read_b64_tr_b16 v[176:177], v51 offset:50176
  ds_read_b64_tr_b16 v[178:179], v51 offset:50688
  ds_read_b64_tr_b16 v[180:181], v51 offset:50208
  ds_read_b64_tr_b16 v[182:183], v51 offset:50720
  ds_read_b64_tr_b16 v[184:185], v51 offset:50240
  ds_read_b64_tr_b16 v[186:187], v51 offset:50752
  ds_read_b64_tr_b16 v[188:189], v51 offset:50272
  ds_read_b64_tr_b16 v[190:191], v51 offset:50784
  ds_read_b64_tr_b16 v[192:193], v51 offset:54272
  ds_read_b64_tr_b16 v[194:195], v51 offset:54784
  ds_read_b64_tr_b16 v[196:197], v51 offset:54304
  ds_read_b64_tr_b16 v[198:199], v51 offset:54816
  ds_read_b64_tr_b16 v[200:201], v51 offset:54336
  ds_read_b64_tr_b16 v[202:203], v51 offset:54848
  ds_read_b64_tr_b16 v[204:205], v51 offset:54368
  ds_read_b64_tr_b16 v[206:207], v51 offset:54880
  ds_read_b64_tr_b16 v[208:209], v51 offset:58368
  ds_read_b64_tr_b16 v[210:211], v51 offset:58880
  ds_read_b64_tr_b16 v[212:213], v51 offset:58400
  ds_read_b64_tr_b16 v[214:215], v51 offset:58912
  ds_read_b64_tr_b16 v[216:217], v51 offset:58432
  ds_read_b64_tr_b16 v[218:219], v51 offset:58944
  ds_read_b64_tr_b16 v[220:221], v51 offset:58464
  ds_read_b64_tr_b16 v[222:223], v51 offset:58976
  v_lshlrev_b32 v224, 16, v224
  v_lshlrev_b32 v225, 16, v225
  v_lshlrev_b32 v226, 16, v226
  v_lshlrev_b32 v227, 16, v227
  s_mov_b32 s86, 0
L_poll_76:
  ds_read_b32 v50, v45 offset:29268
  s_waitcnt lgkmcnt(0)
  v_cmp_ne_u32 vcc, 1, v50
  s_nop 0
  s_cmp_eq_u64 vcc, 0
  s_cbranch_scc1 L_pok_77
  s_add_u32 s86, s86, 1
  s_cmp_gt_u32 s86, 0x20000
  s_cbranch_scc1 L_pok_77
  s_sleep 1
  s_branch L_poll_76
L_pok_77:
  ds_read_b128 v[104:107], v46 offset:25024
  ds_read_b128 v[108:111], v46 offset:25088
  ds_read_b128 v[112:115], v46 offset:25152
  ds_read_b128 v[116:119], v46 offset:25216
  s_waitcnt lgkmcnt(3)
  v_mfma_f32_16x16x32_bf16 v[64:67], v[104:107], v[160:163], v[64:67]
  v_mfma_f32_16x16x32_bf16 v[68:71], v[104:107], v[164:167], v[68:71]
  v_mfma_f32_16x16x32_bf16 v[72:75], v[104:107], v[168:171], v[72:75]
  v_mfma_f32_16x16x32_bf16 v[76:79], v[104:107], v[172:175], v[76:79]
  s_waitcnt lgkmcnt(2)
  v_mfma_f32_16x16x32_bf16 v[64:67], v[108:111], v[176:179], v[64:67]
  v_mfma_f32_16x16x32_bf16 v[68:71], v[108:111], v[180:183], v[68:71]
  v_mfma_f32_16x16x32_bf16 v[72:75], v[108:111], v[184:187], v[72:75]
  v_mfma_f32_16x16x32_bf16 v[76:79], v[108:111], v[188:191], v[76:79]
  s_waitcnt lgkmcnt(1)
  v_mfma_f32_16x16x32_bf16 v[64:67], v[112:115], v[192:195], v[64:67]
  v_mfma_f32_16x16x32_bf16 v[68:71], v[112:115], v[196:199], v[68:71]
  v_mfma_f32_16x16x32_bf16 v[72:75], v[112:115], v[200:203], v[72:75]
  v_mfma_f32_16x16x32_bf16 v[76:79], v[112:115], v[204:207], v[76:79]
  s_waitcnt lgkmcnt(0)
  v_mfma_f32_16x16x32_bf16 v[64:67], v[116:119], v[208:211], v[64:67]
  v_mfma_f32_16x16x32_bf16 v[68:71], v[116:119], v[212:215], v[68:71]
  v_mfma_f32_16x16x32_bf16 v[72:75], v[116:119], v[216:219], v[72:75]
  v_mfma_f32_16x16x32_bf16 v[76:79], v[116:119], v[220:223], v[76:79]
  s_add_u32 s70, s99, 0
  s_add_u32 s71, s99, 4096
  s_add_u32 s72, s99, 8192
  s_add_u32 s73, s99, 12288
  s_mov_b32 s98, 0x41f80000
  s_nop 0
  v_mov_b32_dpp v64, v68 quad_perm:[0,1,2,3] row_mask:0x2 bank_mask:0xf
  v_mov_b32_dpp v65, v69 quad_perm:[0,1,2,3] row_mask:0x2 bank_mask:0xf
  v_mov_b32_dpp v66, v70 quad_perm:[0,1,2,3] row_mask:0x2 bank_mask:0xf
  v_mov_b32_dpp v67, v71 quad_perm:[0,1,2,3] row_mask:0x2 bank_mask:0xf
  v_mov_b32_dpp v64, v72 quad_perm:[0,1,2,3] row_mask:0x4 bank_mask:0xf
  v_mov_b32_dpp v65, v73 quad_perm:[0,1,2,3] row_mask:0x4 bank_mask:0xf
  v_mov_b32_dpp v66, v74 quad_perm:[0,1,2,3] row_mask:0x4 bank_mask:0xf
  v_mov_b32_dpp v67, v75 quad_perm:[0,1,2,3] row_mask:0x4 bank_mask:0xf
  v_mov_b32_dpp v64, v76 quad_perm:[0,1,2,3] row_mask:0x8 bank_mask:0xf
  v_mov_b32_dpp v65, v77 quad_perm:[0,1,2,3] row_mask:0x8 bank_mask:0xf
  v_mov_b32_dpp v66, v78 quad_perm:[0,1,2,3] row_mask:0x8 bank_mask:0xf
  v_mov_b32_dpp v67, v79 quad_perm:[0,1,2,3] row_mask:0x8 bank_mask:0xf
  v_cndmask_b32 v84, 1.0, v64, s[90:91]
  v_cndmask_b32 v86, 1.0, v65, s[90:91]
  v_cndmask_b32 v88, 1.0, v66, s[90:91]
  v_cndmask_b32 v90, 1.0, v67, s[90:91]
  s_mov_b32 exec_lo, 0x01ff01ff
  s_mov_b32 exec_hi, 0x01ff01ff
  buffer_atomic_add_f32 v84, v96, s[52:55], s70 offen sc0
  buffer_atomic_add_f32 v86, v96, s[52:55], s71 offen sc0
  buffer_atomic_add_f32 v88, v96, s[52:55], s72 offen sc0
  buffer_atomic_add_f32 v90, v96, s[52:55], s73 offen sc0
  s_mov_b64 exec, -1
  v_mov_b32 v85, 1.0
  v_cndmask_b32 v85, v64, v85, s[90:91]
  v_mov_b32 v87, 1.0
  v_cndmask_b32 v87, v65, v87, s[90:91]
  v_mov_b32 v89, 1.0
  v_cndmask_b32 v89, v66, v89, s[90:91]
  v_mov_b32 v91, 1.0
  v_cndmask_b32 v91, v67, v91, s[90:91]
  s_mov_b32 exec_lo, 0xff80ff80
  s_mov_b32 exec_hi, 0xff80ff80
  buffer_atomic_add_f32 v85, v97, s[52:55], s70 offen sc0
  buffer_atomic_add_f32 v87, v97, s[52:55], s71 offen sc0
  buffer_atomic_add_f32 v89, v97, s[52:55], s72 offen sc0
  buffer_atomic_add_f32 v91, v97, s[52:55], s73 offen sc0
  s_mov_b64 exec, -1
  s_waitcnt vmcnt(0)
  v_mov_b32_dpp v100, v84 row_newbcast:8 row_mask:0xf bank_mask:0x3
  v_mov_b32_dpp v100, v85 row_newbcast:7 row_mask:0xf bank_mask:0xc
  v_mov_b32_dpp v101, v86 row_newbcast:8 row_mask:0xf bank_mask:0x3
  v_mov_b32_dpp v101, v87 row_newbcast:7 row_mask:0xf bank_mask:0xc
  v_mov_b32_dpp v102, v88 row_newbcast:8 row_mask:0xf bank_mask:0x3
  v_mov_b32_dpp v102, v89 row_newbcast:7 row_mask:0xf bank_mask:0xc
  v_mov_b32_dpp v103, v90 row_newbcast:8 row_mask:0xf bank_mask:0x3
  v_mov_b32_dpp v103, v91 row_newbcast:7 row_mask:0xf bank_mask:0xc
  v_cndmask_b32 v84, v85, v84, s[90:91]
  v_add_f32 v64, v64, v84
  v_cvt_pk_bf16_f32 v64, v64, v64
  v_lshlrev_b32 v64, 16, v64
  v_cndmask_b32 v86, v87, v86, s[90:91]
  v_add_f32 v65, v65, v86
  v_cvt_pk_bf16_f32 v65, v65, v65
  v_lshlrev_b32 v65, 16, v65
  v_cndmask_b32 v88, v89, v88, s[90:91]
  v_add_f32 v66, v66, v88
  v_cvt_pk_bf16_f32 v66, v66, v66
  v_lshlrev_b32 v66, 16, v66
  v_cndmask_b32 v90, v91, v90, s[90:91]
  v_add_f32 v67, v67, v90
  v_cvt_pk_bf16_f32 v67, v67, v67
  v_lshlrev_b32 v67, 16, v67
  v_add_f32 v64, v64, v224
  s_nop 1
  v_mov_b32_dpp v68, v64 quad_perm:[1,0,3,2] row_mask:0xf bank_mask:0xf
  v_cvt_pk_bf16_f32 v68, v64, v68
  v_mov_b32 v69, s81
  v_add_f32 v65, v65, v225
  s_nop 1
  v_mov_b32_dpp v70, v65 quad_perm:[1,0,3,2] row_mask:0xf bank_mask:0xf
  v_cvt_pk_bf16_f32 v70, v65, v70
  v_mov_b32 v71, s81
  v_add_f32 v66, v66, v226
  s_nop 1
  v_mov_b32_dpp v72, v66 quad_perm:[1,0,3,2] row_mask:0xf bank_mask:0xf
  v_cvt_pk_bf16_f32 v72, v66, v72
  v_mov_b32 v73, s81
  v_add_f32 v67, v67, v227
  s_nop 1
  v_mov_b32_dpp v74, v67 quad_perm:[1,0,3,2] row_mask:0xf bank_mask:0xf
  v_cvt_pk_bf16_f32 v74, v67, v74
  v_mov_b32 v75, s81
  v_cmp_eq_u32 vcc, s98, v100
  s_nop 0
  s_and_b32 vcc_lo, vcc_lo, 0x55555555
  s_and_b32 vcc_hi, vcc_hi, 0x55555555
  s_cmp_eq_u64 vcc, 0
  s_cbranch_scc1 L_nh_78
  s_mov_b64 exec, vcc
  s_add_u32 s70, s100, 0
  buffer_store_dwordx2 v[68:69], v121, s[52:55], s70 offen sc1
  s_mov_b64 exec, -1
L_nh_78:
  v_cmp_eq_u32 vcc, s98, v101
  s_nop 0
  s_and_b32 vcc_lo, vcc_lo, 0x55555555
  s_and_b32 vcc_hi, vcc_hi, 0x55555555
  s_cmp_eq_u64 vcc, 0
  s_cbranch_scc1 L_nh_79
  s_mov_b64 exec, vcc
  s_add_u32 s70, s100, 2048
  buffer_store_dwordx2 v[70:71], v121, s[52:55], s70 offen sc1
  s_mov_b64 exec, -1
L_nh_79:
  v_cmp_eq_u32 vcc, s98, v102
  s_nop 0
  s_and_b32 vcc_lo, vcc_lo, 0x55555555
  s_and_b32 vcc_hi, vcc_hi, 0x55555555
  s_cmp_eq_u64 vcc, 0
  s_cbranch_scc1 L_nh_80
  s_mov_b64 exec, vcc
  s_add_u32 s70, s100, 4096
  buffer_store_dwordx2 v[72:73], v121, s[52:55], s70 offen sc1
  s_mov_b64 exec, -1
L_nh_80:
  v_cmp_eq_u32 vcc, s98, v103
  s_nop 0
  s_and_b32 vcc_lo, vcc_lo, 0x55555555
  s_and_b32 vcc_hi, vcc_hi, 0x55555555
  s_cmp_eq_u64 vcc, 0
  s_cbranch_scc1 L_nh_81
  s_mov_b64 exec, vcc
  s_add_u32 s70, s100, 6144
  buffer_store_dwordx2 v[74:75], v121, s[52:55], s70 offen sc1
  s_mov_b64 exec, -1
L_nh_81:
  s_branch L_H_fin
L_H_role:
  s_cmp_lt_u32 s89, 43
  s_cbranch_scc1 L_H_r2
L_H_fin:
  s_endpgm
L_H_r2:
  s_mov_b32 s90, 0x00ff00ff
  s_mov_b32 s91, 0x00ff00ff
  v_lshrrev_b32 v48, 3, v37
  v_lshl_add_u32 v48, v36, 1, v48
  v_lshlrev_b32 v48, 6, v48
  v_and_b32 v49, 7, v37
  v_lshl_add_u32 v48, v49, 2, v48
  v_lshlrev_b32 v49, 7, v36
  v_add_u32 v50, 32, v49
  v_add_u32 v49, 96, v49
  v_cndmask_b32 v97, v48, v49, s[90:91]
  v_cndmask_b32 v96, v50, v48, s[90:91]
  v_lshl_add_u32 v99, v36, 4, v37
  s_lshl_b32 s70, s3, 6
  v_add_u32 v99, s70, v99
  v_lshlrev_b32 v99, 1, v99
  s_lshl_b32 s99, s3, 9
  s_add_u32 s99, s99, 24576
  s_mov_b32 s48, s34
  s_mov_b32 s49, s35
  s_mov_b32 s50, 4096
  s_mov_b32 s51, 0x20000
  v_and_b32 v114, 3, v37
  v_lshlrev_b32 v114, 6, v114
  v_lshl_add_u32 v114, v36, 4, v114
  v_and_b32 v46, 1, v2
  v_lshlrev_b32 v46, 2, v46
  s_mov_b32 s86, 0
L_poll_82:
  ds_read_b32 v47, v46 offset:29240
  s_waitcnt lgkmcnt(0)
  v_cmp_ne_u32 vcc, 1, v47
  s_nop 0
  s_cmp_eq_u64 vcc, 0
  s_cbranch_scc1 L_pok_83
  s_add_u32 s86, s86, 1
  s_cmp_gt_u32 s86, 0x20000
  s_cbranch_scc1 L_pok_83
  s_sleep 2
  s_branch L_poll_82
L_pok_83:
  v_lshrrev_b32 v47, 2, v37
  v_lshl_add_u32 v47, v36, 3, v47
  s_mov_b32 s70, 1056
  v_mul_lo_u32 v47, v47, s70
  v_and_b32 v48, 3, v37
  v_lshl_add_u32 v47, v48, 3, v47
  s_lshl_b32 s70, s3, 7
  s_add_u32 s70, s70, 111616
  v_add_u32 v47, s70, v47
  ds_read_b64_tr_b16 v[232:233], v47 offset:0
  ds_read_b64_tr_b16 v[234:235], v47 offset:4224
  ds_read_b64_tr_b16 v[236:237], v47 offset:32
  ds_read_b64_tr_b16 v[238:239], v47 offset:4256
  ds_read_b64_tr_b16 v[240:241], v47 offset:64
  ds_read_b64_tr_b16 v[242:243], v47 offset:4288
  ds_read_b64_tr_b16 v[244:245], v47 offset:96
  ds_read_b64_tr_b16 v[246:247], v47 offset:4320
  s_barrier
  s_barrier
  s_branch L_barC
L_ctl:
  v_mov_b32 v54, 0x3e2a3d71
  v_mov_b32 v55, 0xbe800000
  v_mov_b32 v60, 0x3c000000
  v_mov_b32 v61, 0x40000000
  s_cmp_lt_u32 s89, 43
  s_mov_b32 s41, 0x40900000
  s_cselect_b32 s40, s41, 0x3fbf6629
  s_lshr_b32 s42, s80, 3
  s_cmp_eq_u32 s42, 28
  s_mov_b32 s41, 0x40e00000
  s_cselect_b32 s40, s41, s40
  v_mov_b32 v61, s40
  v_mov_b32 v62, 0x3f99999a
  v_mov_b32 v63, 0xc0000000
  v_mov_b32 v66, 0x00000000
  v_mov_b32 v67, 0
  v_lshlrev_b32 v49, 2, v2
  v_and_b32 v44, 12, v49
  v_mov_b32 v48, 0
  s_and_b32 s71, s80, 7
  s_lshl_b32 s78, s71, 8
  s_add_u32 s78, s78, 1280000
  s_lshl_b32 s71, s71, 8
  s_add_u32 s71, s71, 1277952
  s_lshr_b32 s70, s80, 3
  s_lshl_b32 s70, s70, 2
  s_add_u32 s70, s70, s71
  s_and_b32 s72, s81, 0x1fffff
  s_lshl_b32 s73, s72, 11
  s_lshl_b32 s79, s81, 16
  s_mov_b32 s86, 0
L_ctop_84:
  ds_read_b32 v45, v44 offset:29184
  ds_read_b32 v46, v44 offset:29200
  s_waitcnt lgkmcnt(0)
  v_add_u32_dpp v47, v45, v45 quad_perm:[1,0,3,2] row_mask:0xf bank_mask:0xf
  s_nop 1
  v_add_u32_dpp v47, v47, v47 quad_perm:[2,3,0,1] row_mask:0xf bank_mask:0xf
  v_or_b32 v47, s73, v47
  s_mov_b64 exec, 1
  buffer_store_dword v47, v48, s[52:55], s70 offen
  s_mov_b32 exec_lo, -1
  s_mov_b32 exec_hi, 3
  buffer_load_dword v50, v49, s[52:55], s71 offen nt
  v_and_b32 v52, 7, v45
  v_sub_u32 v52, 8, v52
  v_cvt_f32_u32 v52, v52
  v_mov_b32 v53, 0
  v_cmp_eq_u32 vcc, 6, v46
  s_nop 1
  v_cndmask_b32 v53, v53, v54, vcc
  v_cmp_eq_u32 vcc, 4, v46
  s_nop 1
  v_cndmask_b32 v53, v53, v55, vcc
  v_mul_f32 v52, v52, v53
  v_cvt_f32_u32 v51, v45
  v_add_f32 v52, v52, v51
  s_waitcnt vmcnt(0)
  v_readlane_b32 s76, v50, 32
  v_readlane_b32 s77, v50, 33
  v_lshrrev_b32 v53, 11, v50
  v_cmp_eq_u32 vcc, s72, v53
  v_and_b32 v50, 0x7ff, v50
  s_cmp_eq_u32 vcc_lo, -1
  s_cselect_b32 s75, 1, 0
  v_add_u32_dpp v50, v50, v50 row_ror:8 row_mask:0xf bank_mask:0xf
  s_nop 1
  v_add_u32_dpp v50, v50, v50 row_ror:4 row_mask:0xf bank_mask:0xf
  s_nop 1
  v_add_u32_dpp v50, v50, v50 row_ror:2 row_mask:0xf bank_mask:0xf
  s_nop 1
  v_add_u32_dpp v50, v50, v50 row_ror:1 row_mask:0xf bank_mask:0xf
  s_nop 0
  v_readlane_b32 s74, v50, 0
  v_readlane_b32 s40, v50, 16
  s_nop 0
  s_add_u32 s74, s74, s40
  s_cmp_eq_u32 s75, 0
  s_cbranch_scc1 L_cskip_86
  s_lshr_b32 s40, s80, 3
  s_cmp_lg_u32 s40, 28
  s_cbranch_scc1 L_cnog_87
  s_and_b32 s40, s86, 1
  s_cmp_lg_u32 s40, 0
  s_cbranch_scc1 L_cnog_87
  s_or_b32 s40, s79, s74
  v_mov_b32 v65, s40
  v_mov_b32 v64, s40
  s_mov_b64 exec, 1
  buffer_store_dword v65, v48, s[52:55], s78 offen sc1
  s_mov_b64 exec, 0xff
  s_mov_b32 s41, 1280000
  v_lshlrev_b32 v53, 8, v2
  buffer_load_dword v64, v53, s[52:55], s41 offen sc1
  s_waitcnt vmcnt(0)
  s_and_b32 s41, s80, 7
  v_cmp_eq_u32 vcc, s41, v2
  s_nop 1
  v_cndmask_b32 v64, v64, v65, vcc
  v_xor_b32 v53, v64, v65
  v_cmp_gt_u32 vcc, 0x10000, v53
  s_nop 1
  v_cndmask_b32 v64, v65, v64, vcc
  v_and_b32 v64, 0xffff, v64
  s_nop 1
  v_add_u32_dpp v64, v64, v64 row_half_mirror row_mask:0xf bank_mask:0xf
  s_nop 1
  v_add_u32_dpp v64, v64, v64 quad_perm:[1,0,3,2] row_mask:0xf bank_mask:0xf
  s_nop 1
  v_add_u32_dpp v64, v64, v64 quad_perm:[2,3,0,1] row_mask:0xf bank_mask:0xf
  v_cvt_f32_u32 v64, v64
  v_cvt_f32_u32 v65, s74
  v_mul_f32 v64, 0x3e000000, v64
  v_sub_f32 v64, v64, v65
  v_mul_f32 v64, v64, v60
  v_add_f32 v64, 0x409ccccd, v64
  v_mov_b32 v65, s81
  v_readfirstlane_b32 s76, v64
  s_mov_b32 s77, s81
  s_mov_b64 exec, 1
  buffer_store_dwordx2 v[64:65], v48, s[52:55], s71 offen offset:128
  s_mov_b64 exec, 0xffffffff
L_cnog_87:
  s_cmp_eq_u32 s77, s81
  s_cselect_b32 s76, s76, 0
  v_cvt_f32_u32 v51, s74
  v_fma_f32 v51, v51, v60, v61
  v_add_f32 v51, s76, v51
  v_sub_f32 v51, v51, v52
  v_mov_b32 v53, 5
  v_cmp_lt_f32 vcc, v62, v51
  s_nop 1
  v_cndmask_b32 v53, v53, 6, vcc
  v_cmp_gt_f32 vcc, v63, v51
  s_nop 1
  v_cndmask_b32 v53, v53, 4, vcc
  s_mov_b64 exec, 0xf
  ds_write_b32 v44, v53 offset:29216
L_cskip_86:
  s_mov_b64 exec, -1
  s_nop 0
  v_min_u32_dpp v53, v45, v45 quad_perm:[1,0,3,2] row_mask:0xf bank_mask:0xf
  s_nop 1
  v_min_u32_dpp v53, v53, v53 quad_perm:[2,3,0,1] row_mask:0xf bank_mask:0xf
  s_nop 0
  v_readfirstlane_b32 s74, v53
  s_nop 0
  s_cmp_ge_u32 s74, 248
  s_cbranch_scc1 L_cdone_85
  s_add_u32 s86, s86, 1
  s_cmp_gt_u32 s86, 0x4000
  s_cbranch_scc1 L_cdone_85
  s_sleep 12
  s_branch L_ctop_84
L_cdone_85:
  s_branch L_H_role
L_H_dma:
  s_cmp_lt_u32 s89, 43
  s_cbranch_scc1 L_H_dma2
  s_cmp_lg_u32 s3, 5
  s_cbranch_scc1 L_H_fin
  s_cmp_gt_u32 s85, 7
  s_cbranch_scc1 L_H_fin
  s_branch L_H_sub
L_H_dma2:
  s_sub_u32 s74, s3, 5
  v_lshlrev_b32 v48, 4, v2
  s_mov_b32 s56, s32
  s_mov_b32 s57, s33
  s_mov_b32 s58, 1409024
  s_mov_b32 s59, 0x20000
  s_lshl_b32 s70, s89, 15
  s_lshl_b32 s73, s74, 14
  s_add_u32 s70, s70, s73
  s_mul_i32 s71, s74, 16896
  s_add_u32 s71, s71, 111616
  s_add_u32 s72, s70, 0
  s_add_u32 m0, s71, 0
  s_nop 0
  buffer_load_dwordx4 v48, s[56:59], s72 offen nt lds
  s_waitcnt vmcnt(0)
  s_add_u32 s72, s70, 1024
  s_add_u32 m0, s71, 1056
  s_nop 0
  buffer_load_dwordx4 v48, s[56:59], s72 offen nt lds
  s_waitcnt vmcnt(0)
  s_add_u32 s72, s70, 2048
  s_add_u32 m0, s71, 2112
  s_nop 0
  buffer_load_dwordx4 v48, s[56:59], s72 offen nt lds
  s_waitcnt vmcnt(0)
  s_add_u32 s72, s70, 3072
  s_add_u32 m0, s71, 3168
  s_nop 0
  buffer_load_dwordx4 v48, s[56:59], s72 offen nt lds
  s_waitcnt vmcnt(0)
  s_add_u32 s72, s70, 4096
  s_add_u32 m0, s71, 4224
  s_nop 0
  buffer_load_dwordx4 v48, s[56:59], s72 offen nt lds
  s_waitcnt vmcnt(0)
  s_add_u32 s72, s70, 5120
  s_add_u32 m0, s71, 5280
  s_nop 0
  buffer_load_dwordx4 v48, s[56:59], s72 offen nt lds
  s_waitcnt vmcnt(0)
  s_add_u32 s72, s70, 6144
  s_add_u32 m0, s71, 6336
  s_nop 0
  buffer_load_dwordx4 v48, s[56:59], s72 offen nt lds
  s_waitcnt vmcnt(0)
  s_add_u32 s72, s70, 7168
  s_add_u32 m0, s71, 7392
  s_nop 0
  buffer_load_dwordx4 v48, s[56:59], s72 offen nt lds
  s_waitcnt vmcnt(0)
  s_add_u32 s72, s70, 8192
  s_add_u32 m0, s71, 8448
  s_nop 0
  buffer_load_dwordx4 v48, s[56:59], s72 offen nt lds
  s_waitcnt vmcnt(0)
  s_add_u32 s72, s70, 9216
  s_add_u32 m0, s71, 9504
  s_nop 0
  buffer_load_dwordx4 v48, s[56:59], s72 offen nt lds
  s_waitcnt vmcnt(0)
  s_add_u32 s72, s70, 10240
  s_add_u32 m0, s71, 10560
  s_nop 0
  buffer_load_dwordx4 v48, s[56:59], s72 offen nt lds
  s_waitcnt vmcnt(0)
  s_add_u32 s72, s70, 11264
  s_add_u32 m0, s71, 11616
  s_nop 0
  buffer_load_dwordx4 v48, s[56:59], s72 offen nt lds
  s_waitcnt vmcnt(0)
  s_add_u32 s72, s70, 12288
  s_add_u32 m0, s71, 12672
  s_nop 0
  buffer_load_dwordx4 v48, s[56:59], s72 offen nt lds
  s_waitcnt vmcnt(0)
  s_add_u32 s72, s70, 13312
  s_add_u32 m0, s71, 13728
  s_nop 0
  buffer_load_dwordx4 v48, s[56:59], s72 offen nt lds
  s_waitcnt vmcnt(0)
  s_add_u32 s72, s70, 14336
  s_add_u32 m0, s71, 14784
  s_nop 0
  buffer_load_dwordx4 v48, s[56:59], s72 offen nt lds
  s_waitcnt vmcnt(0)
  s_add_u32 s72, s70, 15360
  s_add_u32 m0, s71, 15840
  s_nop 0
  buffer_load_dwordx4 v48, s[56:59], s72 offen nt lds
  s_waitcnt vmcnt(0)
  s_lshl_b32 s70, s74, 2
  v_mov_b32 v46, s70
  v_mov_b32 v47, 1
  s_waitcnt vmcnt(0)
  ds_write_b32 v46, v47 offset:29240
  s_branch L_H_r2
L_S:
  v_lshlrev_b32 v1, 4, v0
  s_mov_b32 s66, 0xcccccccc
  s_mov_b32 s67, 0xcccccccc
  s_mov_b32 s68, 0xaaaaaaaa
  s_mov_b32 s69, 0xaaaaaaaa
  s_mov_b32 s82, 0x3db504f3
  s_mov_b32 s83, 0x3fb8aa3b
  s_waitcnt lgkmcnt(0)
  s_load_dword s81, s[38:39], 0
  s_mov_b32 s40, s18
  s_mov_b32 s41, s19
  s_mov_b32 s42, 268435456
  s_mov_b32 s43, 0x20000
  s_barrier
  buffer_load_dwordx4 v[96:99], v1, s[40:43], s64 offen nt
  s_add_u32 s64, s64, 4096
  buffer_load_dwordx4 v[100:103], v1, s[40:43], s64 offen nt
  s_add_u32 s64, s64, 4096
  buffer_load_dwordx4 v[104:107], v1, s[40:43], s64 offen nt
  s_add_u32 s64, s64, 4096
  buffer_load_dwordx4 v[108:111], v1, s[40:43], s64 offen nt
  s_add_u32 s64, s64, 4096
  buffer_load_dwordx4 v[112:115], v1, s[40:43], s64 offen nt
  s_add_u32 s64, s64, 4096
  buffer_load_dwordx4 v[116:119], v1, s[40:43], s64 offen nt
  s_add_u32 s64, s64, 4096
  buffer_load_dwordx4 v[120:123], v1, s[40:43], s64 offen nt
  s_add_u32 s64, s64, 4096
  s_mov_b32 s52, s38
  s_mov_b32 s53, s39
  s_mov_b32 s54, 3473408
  s_mov_b32 s55, 0x20000
  s_lshl_b32 s70, s3, 9
  v_lshlrev_b32 v39, 5, v37
  v_lshl_add_u32 v39, v36, 3, v39
  v_add_u32 v39, s70, v39
  s_lshl_b32 s70, s3, 12
  v_lshlrev_b32 v41, 2, v2
  v_add_u32 v41, s70, v41
  v_mov_b32 v18, 0xff800000
  s_waitcnt lgkmcnt(0)
  s_add_u32 s81, s81, 1
  buffer_load_dwordx4 v[124:127], v1, s[40:43], s64 offen nt
  s_add_u32 s64, s64, 4096
  buffer_load_dwordx4 v[128:131], v1, s[40:43], s64 offen nt
  s_add_u32 s64, s64, 4096
  s_waitcnt vmcnt(8)
  buffer_load_dwordx4 v[132:135], v1, s[40:43], s64 offen nt
  s_add_u32 s64, s64, 4096
  s_waitcnt vmcnt(8)
  buffer_load_dwordx4 v[136:139], v1, s[40:43], s64 offen nt
  s_add_u32 s64, s64, 4096
  s_waitcnt vmcnt(8)
  buffer_load_dwordx4 v[140:143], v1, s[40:43], s64 offen nt
  s_add_u32 s64, s64, 4096
  s_waitcnt vmcnt(8)
  buffer_load_dwordx4 v[144:147], v1, s[40:43], s64 offen nt
  s_add_u32 s64, s64, 4096
  s_waitcnt vmcnt(8)
  buffer_load_dwordx4 v[148:151], v1, s[40:43], s64 offen nt
  s_add_u32 s64, s64, 4096
  s_waitcnt vmcnt(8)
  buffer_load_dwordx4 v[152:155], v1, s[40:43], s64 offen nt
  s_add_u32 s64, s64, 4096
  s_waitcnt vmcnt(8)
  buffer_load_dwordx4 v[156:159], v1, s[40:43], s64 offen nt
  s_add_u32 s64, s64, 4096
  s_waitcnt vmcnt(8)
  buffer_load_dwordx4 v[160:163], v1, s[40:43], s64 offen nt
  s_add_u32 s64, s64, 4096
  s_waitcnt vmcnt(8)
  buffer_load_dwordx4 v[164:167], v1, s[40:43], s64 offen nt
  s_add_u32 s64, s64, 4096
  s_waitcnt vmcnt(8)
  buffer_load_dwordx4 v[168:171], v1, s[40:43], s64 offen nt
  s_add_u32 s64, s64, 4096
  s_waitcnt vmcnt(8)
  buffer_load_dwordx4 v[172:175], v1, s[40:43], s64 offen nt
  s_add_u32 s64, s64, 4096
  s_waitcnt vmcnt(8)
  buffer_load_dwordx4 v[176:179], v1, s[40:43], s64 offen nt
  s_add_u32 s64, s64, 4096
  s_waitcnt vmcnt(8)
  buffer_load_dwordx4 v[180:183], v1, s[40:43], s64 offen nt
  s_add_u32 s64, s64, 4096
  s_waitcnt vmcnt(8)
  buffer_load_dwordx4 v[184:187], v1, s[40:43], s64 offen nt
  s_add_u32 s64, s64, 4096
  s_waitcnt vmcnt(8)
  buffer_load_dwordx4 v[188:191], v1, s[40:43], s64 offen nt
  s_add_u32 s64, s64, 4096
  s_waitcnt vmcnt(8)
  buffer_load_dwordx4 v[192:195], v1, s[40:43], s64 offen nt
  s_add_u32 s64, s64, 4096
  s_waitcnt vmcnt(8)
  buffer_load_dwordx4 v[196:199], v1, s[40:43], s64 offen nt
  s_add_u32 s64, s64, 4096
  s_waitcnt vmcnt(8)
  buffer_load_dwordx4 v[200:203], v1, s[40:43], s64 offen nt
  s_add_u32 s64, s64, 4096
  s_waitcnt vmcnt(8)
  buffer_load_dwordx4 v[204:207], v1, s[40:43], s64 offen nt
  s_add_u32 s64, s64, 4096
  s_waitcnt vmcnt(8)
  buffer_load_dwordx4 v[208:211], v1, s[40:43], s64 offen nt
  s_add_u32 s64, s64, 4096
  s_waitcnt vmcnt(8)
  buffer_load_dwordx4 v[212:215], v1, s[40:43], s64 offen nt
  s_add_u32 s64, s64, 4096
  s_waitcnt vmcnt(8)
  buffer_load_dwordx4 v[216:219], v1, s[40:43], s64 offen nt
  s_add_u32 s64, s64, 4096
  s_waitcnt vmcnt(8)
  buffer_load_dwordx4 v[220:223], v1, s[40:43], s64 offen nt
  s_add_u32 s64, s64, 4096
  s_waitcnt vmcnt(8)
  buffer_load_dwordx4 v[64:67], v1, s[40:43], s64 offen nt
  s_add_u32 s64, s64, 4096
  s_waitcnt vmcnt(8)
  buffer_load_dwordx4 v[68:71], v1, s[40:43], s64 offen nt
  s_add_u32 s64, s64, 4096
  s_waitcnt vmcnt(8)
  buffer_load_dwordx4 v[72:75], v1, s[40:43], s64 offen nt
  s_add_u32 s64, s64, 4096
  s_waitcnt vmcnt(8)
  buffer_load_dwordx4 v[76:79], v1, s[40:43], s64 offen nt
  s_add_u32 s64, s64, 4096
  s_waitcnt vmcnt(8)
  buffer_load_dwordx4 v[80:83], v1, s[40:43], s64 offen nt
  s_add_u32 s64, s64, 4096
  s_waitcnt vmcnt(8)
  buffer_load_dwordx4 v[84:87], v1, s[40:43], s64 offen nt
  s_add_u32 s64, s64, 4096
  s_waitcnt vmcnt(8)
  buffer_load_dwordx4 v[88:91], v1, s[40:43], s64 offen nt
  s_add_u32 s64, s64, 4096
  s_barrier
  v_lshlrev_b32 v49, 3, v2
  ds_read_b64 v[20:21], v49 offset:0
  ds_read_b64 v[22:23], v49 offset:512
  ds_read_b64 v[24:25], v49 offset:1024
  ds_read_b64 v[26:27], v49 offset:1536
  s_waitcnt lgkmcnt(0)
  v_add_f32 v20, v20, v22
  v_add_f32 v24, v24, v26
  v_add_f32 v20, v20, v24
  v_add_f32 v21, v21, v23
  v_add_f32 v25, v25, v27
  v_add_f32 v21, v21, v25
  v_cvt_pk_bf16_f32 v20, v20, v21
  s_lshl_b32 s70, s3, 8
  v_lshlrev_b32 v49, 2, v2
  v_add_u32 v49, s70, v49
  ds_write_b32 v49, v20 offset:2048
  v_lshlrev_b32 v49, 4, v37
  v_add_u32 v49, s70, v49
  s_waitcnt lgkmcnt(0)
  ds_read_b128 v[4:7], v49 offset:2048
  s_waitcnt vmcnt(7) lgkmcnt(0)
  v_dot2_f32_bf16 v20, v96, v4, 0
  v_dot2_f32_bf16 v20, v97, v5, v20
  v_dot2_f32_bf16 v20, v98, v6, v20
  v_dot2_f32_bf16 v20, v99, v7, v20
  v_dot2_f32_bf16 v21, v100, v4, 0
  v_dot2_f32_bf16 v21, v101, v5, v21
  v_dot2_f32_bf16 v21, v102, v6, v21
  v_dot2_f32_bf16 v21, v103, v7, v21
  v_dot2_f32_bf16 v22, v104, v4, 0
  v_dot2_f32_bf16 v22, v105, v5, v22
  v_dot2_f32_bf16 v22, v106, v6, v22
  v_dot2_f32_bf16 v22, v107, v7, v22
  v_dot2_f32_bf16 v23, v108, v4, 0
  v_dot2_f32_bf16 v23, v109, v5, v23
  v_dot2_f32_bf16 v23, v110, v6, v23
  v_dot2_f32_bf16 v23, v111, v7, v23
  v_dot2_f32_bf16 v24, v112, v4, 0
  v_dot2_f32_bf16 v24, v113, v5, v24
  v_dot2_f32_bf16 v24, v114, v6, v24
  v_dot2_f32_bf16 v24, v115, v7, v24
  v_dot2_f32_bf16 v25, v116, v4, 0
  v_dot2_f32_bf16 v25, v117, v5, v25
  v_dot2_f32_bf16 v25, v118, v6, v25
  v_dot2_f32_bf16 v25, v119, v7, v25
  v_dot2_f32_bf16 v26, v120, v4, 0
  v_dot2_f32_bf16 v26, v121, v5, v26
  v_dot2_f32_bf16 v26, v122, v6, v26
  v_dot2_f32_bf16 v26, v123, v7, v26
  v_dot2_f32_bf16 v27, v124, v4, 0
  v_dot2_f32_bf16 v27, v125, v5, v27
  v_dot2_f32_bf16 v27, v126, v6, v27
  v_dot2_f32_bf16 v27, v127, v7, v27
  v_dot2_f32_bf16 v28, v128, v4, 0
  v_dot2_f32_bf16 v28, v129, v5, v28
  v_dot2_f32_bf16 v28, v130, v6, v28
  v_dot2_f32_bf16 v28, v131, v7, v28
  v_dot2_f32_bf16 v29, v132, v4, 0
  v_dot2_f32_bf16 v29, v133, v5, v29
  v_dot2_f32_bf16 v29, v134, v6, v29
  v_dot2_f32_bf16 v29, v135, v7, v29
  v_dot2_f32_bf16 v30, v136, v4, 0
  v_dot2_f32_bf16 v30, v137, v5, v30
  v_dot2_f32_bf16 v30, v138, v6, v30
  v_dot2_f32_bf16 v30, v139, v7, v30
  v_dot2_f32_bf16 v31, v140, v4, 0
  v_dot2_f32_bf16 v31, v141, v5, v31
  v_dot2_f32_bf16 v31, v142, v6, v31
  v_dot2_f32_bf16 v31, v143, v7, v31
  v_dot2_f32_bf16 v32, v144, v4, 0
  v_dot2_f32_bf16 v32, v145, v5, v32
  v_dot2_f32_bf16 v32, v146, v6, v32
  v_dot2_f32_bf16 v32, v147, v7, v32
  v_dot2_f32_bf16 v33, v148, v4, 0
  v_dot2_f32_bf16 v33, v149, v5, v33
  v_dot2_f32_bf16 v33, v150, v6, v33
  v_dot2_f32_bf16 v33, v151, v7, v33
  v_dot2_f32_bf16 v34, v152, v4, 0
  v_dot2_f32_bf16 v34, v153, v5, v34
  v_dot2_f32_bf16 v34, v154, v6, v34
  v_dot2_f32_bf16 v34, v155, v7, v34
  v_dot2_f32_bf16 v35, v156, v4, 0
  v_dot2_f32_bf16 v35, v157, v5, v35
  v_dot2_f32_bf16 v35, v158, v6, v35
  v_dot2_f32_bf16 v35, v159, v7, v35
  v_add_f32_dpp v20, v20, v20 row_ror:8 row_mask:0xf bank_mask:0x3
  v_add_f32_dpp v20, v28, v28 row_ror:8 row_mask:0xf bank_mask:0xc
  v_add_f32_dpp v21, v21, v21 row_ror:8 row_mask:0xf bank_mask:0x3
  v_add_f32_dpp v21, v29, v29 row_ror:8 row_mask:0xf bank_mask:0xc
  v_add_f32_dpp v22, v22, v22 row_ror:8 row_mask:0xf bank_mask:0x3
  v_add_f32_dpp v22, v30, v30 row_ror:8 row_mask:0xf bank_mask:0xc
  v_add_f32_dpp v23, v23, v23 row_ror:8 row_mask:0xf bank_mask:0x3
  v_add_f32_dpp v23, v31, v31 row_ror:8 row_mask:0xf bank_mask:0xc
  v_add_f32_dpp v24, v24, v24 row_ror:8 row_mask:0xf bank_mask:0x3
  v_add_f32_dpp v24, v32, v32 row_ror:8 row_mask:0xf bank_mask:0xc
  v_add_f32_dpp v25, v25, v25 row_ror:8 row_mask:0xf bank_mask:0x3
  v_add_f32_dpp v25, v33, v33 row_ror:8 row_mask:0xf bank_mask:0xc
  v_add_f32_dpp v26, v26, v26 row_ror:8 row_mask:0xf bank_mask:0x3
  v_add_f32_dpp v26, v34, v34 row_ror:8 row_mask:0xf bank_mask:0xc
  v_add_f32_dpp v27, v27, v27 row_ror:8 row_mask:0xf bank_mask:0x3
  v_add_f32_dpp v27, v35, v35 row_ror:8 row_mask:0xf bank_mask:0xc
  v_add_f32_dpp v20, v20, v20 row_shl:4 row_mask:0xf bank_mask:0x5
  v_add_f32_dpp v20, v24, v24 row_shr:4 row_mask:0xf bank_mask:0xa
  v_add_f32_dpp v21, v21, v21 row_shl:4 row_mask:0xf bank_mask:0x5
  v_add_f32_dpp v21, v25, v25 row_shr:4 row_mask:0xf bank_mask:0xa
  v_add_f32_dpp v22, v22, v22 row_shl:4 row_mask:0xf bank_mask:0x5
  v_add_f32_dpp v22, v26, v26 row_shr:4 row_mask:0xf bank_mask:0xa
  v_add_f32_dpp v23, v23, v23 row_shl:4 row_mask:0xf bank_mask:0x5
  v_add_f32_dpp v23, v27, v27 row_shr:4 row_mask:0xf bank_mask:0xa
  v_add_f32_dpp v20, v20, v20 quad_perm:[2,3,0,1] row_mask:0xf bank_mask:0xf
  v_add_f32_dpp v21, v21, v21 quad_perm:[2,3,0,1] row_mask:0xf bank_mask:0xf
  v_add_f32_dpp v22, v22, v22 quad_perm:[2,3,0,1] row_mask:0xf bank_mask:0xf
  v_add_f32_dpp v23, v23, v23 quad_perm:[2,3,0,1] row_mask:0xf bank_mask:0xf
  v_cndmask_b32 v20, v20, v22, s[66:67]
  v_cndmask_b32 v21, v21, v23, s[66:67]
  s_nop 0
  v_add_f32_dpp v20, v20, v20 quad_perm:[1,0,3,2] row_mask:0xf bank_mask:0xf
  v_add_f32_dpp v21, v21, v21 quad_perm:[1,0,3,2] row_mask:0xf bank_mask:0xf
  v_cndmask_b32 v20, v20, v21, s[68:69]
  v_cvt_pk_bf16_f32 v20, v20, v20
  v_lshlrev_b32 v20, 16, v20
  v_mul_f32 v20, s82, v20
  v_cvt_pk_bf16_f32 v20, v20, v20
  v_lshlrev_b32 v20, 16, v20
  v_max_f32 v18, v18, v20
  ds_write_b32 v41, v20 offset:4096
  v_add_u32 v41, 256, v41
  v_dot2_f32_bf16 v20, v160, v4, 0
  v_dot2_f32_bf16 v20, v161, v5, v20
  v_dot2_f32_bf16 v20, v162, v6, v20
  v_dot2_f32_bf16 v20, v163, v7, v20
  v_dot2_f32_bf16 v21, v164, v4, 0
  v_dot2_f32_bf16 v21, v165, v5, v21
  v_dot2_f32_bf16 v21, v166, v6, v21
  v_dot2_f32_bf16 v21, v167, v7, v21
  v_dot2_f32_bf16 v22, v168, v4, 0
  v_dot2_f32_bf16 v22, v169, v5, v22
  v_dot2_f32_bf16 v22, v170, v6, v22
  v_dot2_f32_bf16 v22, v171, v7, v22
  v_dot2_f32_bf16 v23, v172, v4, 0
  v_dot2_f32_bf16 v23, v173, v5, v23
  v_dot2_f32_bf16 v23, v174, v6, v23
  v_dot2_f32_bf16 v23, v175, v7, v23
  v_dot2_f32_bf16 v24, v176, v4, 0
  v_dot2_f32_bf16 v24, v177, v5, v24
  v_dot2_f32_bf16 v24, v178, v6, v24
  v_dot2_f32_bf16 v24, v179, v7, v24
  v_dot2_f32_bf16 v25, v180, v4, 0
  v_dot2_f32_bf16 v25, v181, v5, v25
  v_dot2_f32_bf16 v25, v182, v6, v25
  v_dot2_f32_bf16 v25, v183, v7, v25
  v_dot2_f32_bf16 v26, v184, v4, 0
  v_dot2_f32_bf16 v26, v185, v5, v26
  v_dot2_f32_bf16 v26, v186, v6, v26
  v_dot2_f32_bf16 v26, v187, v7, v26
  v_dot2_f32_bf16 v27, v188, v4, 0
  v_dot2_f32_bf16 v27, v189, v5, v27
  v_dot2_f32_bf16 v27, v190, v6, v27
  v_dot2_f32_bf16 v27, v191, v7, v27
  v_dot2_f32_bf16 v28, v192, v4, 0
  v_dot2_f32_bf16 v28, v193, v5, v28
  v_dot2_f32_bf16 v28, v194, v6, v28
  v_dot2_f32_bf16 v28, v195, v7, v28
  v_dot2_f32_bf16 v29, v196, v4, 0
  v_dot2_f32_bf16 v29, v197, v5, v29
  v_dot2_f32_bf16 v29, v198, v6, v29
  v_dot2_f32_bf16 v29, v199, v7, v29
  v_dot2_f32_bf16 v30, v200, v4, 0
  v_dot2_f32_bf16 v30, v201, v5, v30
  v_dot2_f32_bf16 v30, v202, v6, v30
  v_dot2_f32_bf16 v30, v203, v7, v30
  v_dot2_f32_bf16 v31, v204, v4, 0
  v_dot2_f32_bf16 v31, v205, v5, v31
  v_dot2_f32_bf16 v31, v206, v6, v31
  v_dot2_f32_bf16 v31, v207, v7, v31
  v_dot2_f32_bf16 v32, v208, v4, 0
  v_dot2_f32_bf16 v32, v209, v5, v32
  v_dot2_f32_bf16 v32, v210, v6, v32
  v_dot2_f32_bf16 v32, v211, v7, v32
  v_dot2_f32_bf16 v33, v212, v4, 0
  v_dot2_f32_bf16 v33, v213, v5, v33
  v_dot2_f32_bf16 v33, v214, v6, v33
  v_dot2_f32_bf16 v33, v215, v7, v33
  v_dot2_f32_bf16 v34, v216, v4, 0
  v_dot2_f32_bf16 v34, v217, v5, v34
  v_dot2_f32_bf16 v34, v218, v6, v34
  v_dot2_f32_bf16 v34, v219, v7, v34
  v_dot2_f32_bf16 v35, v220, v4, 0
  v_dot2_f32_bf16 v35, v221, v5, v35
  v_dot2_f32_bf16 v35, v222, v6, v35
  v_dot2_f32_bf16 v35, v223, v7, v35
  v_add_f32_dpp v20, v20, v20 row_ror:8 row_mask:0xf bank_mask:0x3
  v_add_f32_dpp v20, v28, v28 row_ror:8 row_mask:0xf bank_mask:0xc
  v_add_f32_dpp v21, v21, v21 row_ror:8 row_mask:0xf bank_mask:0x3
  v_add_f32_dpp v21, v29, v29 row_ror:8 row_mask:0xf bank_mask:0xc
  v_add_f32_dpp v22, v22, v22 row_ror:8 row_mask:0xf bank_mask:0x3
  v_add_f32_dpp v22, v30, v30 row_ror:8 row_mask:0xf bank_mask:0xc
  v_add_f32_dpp v23, v23, v23 row_ror:8 row_mask:0xf bank_mask:0x3
  v_add_f32_dpp v23, v31, v31 row_ror:8 row_mask:0xf bank_mask:0xc
  v_add_f32_dpp v24, v24, v24 row_ror:8 row_mask:0xf bank_mask:0x3
  v_add_f32_dpp v24, v32, v32 row_ror:8 row_mask:0xf bank_mask:0xc
  v_add_f32_dpp v25, v25, v25 row_ror:8 row_mask:0xf bank_mask:0x3
  v_add_f32_dpp v25, v33, v33 row_ror:8 row_mask:0xf bank_mask:0xc
  v_add_f32_dpp v26, v26, v26 row_ror:8 row_mask:0xf bank_mask:0x3
  v_add_f32_dpp v26, v34, v34 row_ror:8 row_mask:0xf bank_mask:0xc
  v_add_f32_dpp v27, v27, v27 row_ror:8 row_mask:0xf bank_mask:0x3
  v_add_f32_dpp v27, v35, v35 row_ror:8 row_mask:0xf bank_mask:0xc
  v_add_f32_dpp v20, v20, v20 row_shl:4 row_mask:0xf bank_mask:0x5
  v_add_f32_dpp v20, v24, v24 row_shr:4 row_mask:0xf bank_mask:0xa
  v_add_f32_dpp v21, v21, v21 row_shl:4 row_mask:0xf bank_mask:0x5
  v_add_f32_dpp v21, v25, v25 row_shr:4 row_mask:0xf bank_mask:0xa
  v_add_f32_dpp v22, v22, v22 row_shl:4 row_mask:0xf bank_mask:0x5
  v_add_f32_dpp v22, v26, v26 row_shr:4 row_mask:0xf bank_mask:0xa
  v_add_f32_dpp v23, v23, v23 row_shl:4 row_mask:0xf bank_mask:0x5
  v_add_f32_dpp v23, v27, v27 row_shr:4 row_mask:0xf bank_mask:0xa
  v_add_f32_dpp v20, v20, v20 quad_perm:[2,3,0,1] row_mask:0xf bank_mask:0xf
  v_add_f32_dpp v21, v21, v21 quad_perm:[2,3,0,1] row_mask:0xf bank_mask:0xf
  v_add_f32_dpp v22, v22, v22 quad_perm:[2,3,0,1] row_mask:0xf bank_mask:0xf
  v_add_f32_dpp v23, v23, v23 quad_perm:[2,3,0,1] row_mask:0xf bank_mask:0xf
  v_cndmask_b32 v20, v20, v22, s[66:67]
  v_cndmask_b32 v21, v21, v23, s[66:67]
  s_nop 0
  v_add_f32_dpp v20, v20, v20 quad_perm:[1,0,3,2] row_mask:0xf bank_mask:0xf
  v_add_f32_dpp v21, v21, v21 quad_perm:[1,0,3,2] row_mask:0xf bank_mask:0xf
  v_cndmask_b32 v20, v20, v21, s[68:69]
  v_cvt_pk_bf16_f32 v20, v20, v20
  v_lshlrev_b32 v20, 16, v20
  v_mul_f32 v20, s82, v20
  v_cvt_pk_bf16_f32 v20, v20, v20
  v_lshlrev_b32 v20, 16, v20
  v_max_f32 v18, v18, v20
  ds_write_b32 v41, v20 offset:4096
  v_add_u32 v41, 256, v41
  s_mov_b32 s65, 2
  s_mov_b32 s101, 5
  s_lshl_b32 s70, s3, 2
  v_mov_b32 v57, s70
  v_mov_b32 v56, 16
  ds_write_b32 v57, v56 offset:29184
L_kloop:
  v_mov_b32 v59, s101
  ds_write_b32 v57, v59 offset:29200
  s_waitcnt vmcnt(6)
  v_dot2_f32_bf16 v20, v64, v4, 0
  v_dot2_f32_bf16 v20, v65, v5, v20
  v_dot2_f32_bf16 v20, v66, v6, v20
  v_dot2_f32_bf16 v20, v67, v7, v20
  s_waitcnt vmcnt(5)
  s_cmp_gt_u32 s101, 5
  s_cbranch_scc1 L_cw_88
  s_waitcnt vmcnt(4)
  s_cmp_eq_u32 s101, 5
  s_cbranch_scc1 L_cw_88
  s_waitcnt vmcnt(3)
L_cw_88:
  buffer_load_dwordx4 v[92:95], v1, s[40:43], s64 offen nt
  s_add_u32 s64, s64, 4096
  s_waitcnt vmcnt(6)
  v_dot2_f32_bf16 v21, v68, v4, 0
  v_dot2_f32_bf16 v21, v69, v5, v21
  v_dot2_f32_bf16 v21, v70, v6, v21
  v_dot2_f32_bf16 v21, v71, v7, v21
  s_waitcnt vmcnt(5)
  s_cmp_gt_u32 s101, 5
  s_cbranch_scc1 L_cw_89
  s_waitcnt vmcnt(4)
  s_cmp_eq_u32 s101, 5
  s_cbranch_scc1 L_cw_89
  s_waitcnt vmcnt(3)
L_cw_89:
  buffer_load_dwordx4 v[64:67], v1, s[40:43], s64 offen nt
  s_add_u32 s64, s64, 4096
  v_add_u32 v56, 1, v56
  ds_write_b32 v57, v56 offset:29184
  s_waitcnt vmcnt(6)
  v_dot2_f32_bf16 v22, v72, v4, 0
  v_dot2_f32_bf16 v22, v73, v5, v22
  v_dot2_f32_bf16 v22, v74, v6, v22
  v_dot2_f32_bf16 v22, v75, v7, v22
  s_waitcnt vmcnt(5)
  s_cmp_gt_u32 s101, 5
  s_cbranch_scc1 L_cw_90
  s_waitcnt vmcnt(4)
  s_cmp_eq_u32 s101, 5
  s_cbranch_scc1 L_cw_90
  s_waitcnt vmcnt(3)
L_cw_90:
  buffer_load_dwordx4 v[68:71], v1, s[40:43], s64 offen nt
  s_add_u32 s64, s64, 4096
  s_waitcnt vmcnt(6)
  v_dot2_f32_bf16 v23, v76, v4, 0
  v_dot2_f32_bf16 v23, v77, v5, v23
  v_dot2_f32_bf16 v23, v78, v6, v23
  v_dot2_f32_bf16 v23, v79, v7, v23
  s_waitcnt vmcnt(5)
  s_cmp_gt_u32 s101, 5
  s_cbranch_scc1 L_cw_91
  s_waitcnt vmcnt(4)
  s_cmp_eq_u32 s101, 5
  s_cbranch_scc1 L_cw_91
  s_waitcnt vmcnt(3)
L_cw_91:
  buffer_load_dwordx4 v[72:75], v1, s[40:43], s64 offen nt
  s_add_u32 s64, s64, 4096
  v_add_u32 v56, 1, v56
  ds_write_b32 v57, v56 offset:29184
  s_waitcnt vmcnt(6)
  v_dot2_f32_bf16 v24, v80, v4, 0
  v_dot2_f32_bf16 v24, v81, v5, v24
  v_dot2_f32_bf16 v24, v82, v6, v24
  v_dot2_f32_bf16 v24, v83, v7, v24
  s_waitcnt vmcnt(5)
  s_cmp_gt_u32 s101, 5
  s_cbranch_scc1 L_cw_92
  s_waitcnt vmcnt(4)
  s_cmp_eq_u32 s101, 5
  s_cbranch_scc1 L_cw_92
  s_waitcnt vmcnt(3)
L_cw_92:
  buffer_load_dwordx4 v[76:79], v1, s[40:43], s64 offen nt
  s_add_u32 s64, s64, 4096
  s_waitcnt vmcnt(6)
  v_dot2_f32_bf16 v25, v84, v4, 0
  v_dot2_f32_bf16 v25, v85, v5, v25
  v_dot2_f32_bf16 v25, v86, v6, v25
  v_dot2_f32_bf16 v25, v87, v7, v25
  s_waitcnt vmcnt(5)
  s_cmp_gt_u32 s101, 5
  s_cbranch_scc1 L_cw_93
  s_waitcnt vmcnt(4)
  s_cmp_eq_u32 s101, 5
  s_cbranch_scc1 L_cw_93
  s_waitcnt vmcnt(3)
L_cw_93:
  buffer_load_dwordx4 v[80:83], v1, s[40:43], s64 offen nt
  s_add_u32 s64, s64, 4096
  v_add_u32 v56, 1, v56
  ds_write_b32 v57, v56 offset:29184
  s_waitcnt vmcnt(6)
  v_dot2_f32_bf16 v26, v88, v4, 0
  v_dot2_f32_bf16 v26, v89, v5, v26
  v_dot2_f32_bf16 v26, v90, v6, v26
  v_dot2_f32_bf16 v26, v91, v7, v26
  s_waitcnt vmcnt(5)
  s_cmp_gt_u32 s101, 5
  s_cbranch_scc1 L_cw_94
  s_waitcnt vmcnt(4)
  s_cmp_eq_u32 s101, 5
  s_cbranch_scc1 L_cw_94
  s_waitcnt vmcnt(3)
L_cw_94:
  buffer_load_dwordx4 v[84:87], v1, s[40:43], s64 offen nt
  s_add_u32 s64, s64, 4096
  s_waitcnt vmcnt(6)
  v_dot2_f32_bf16 v27, v92, v4, 0
  v_dot2_f32_bf16 v27, v93, v5, v27
  v_dot2_f32_bf16 v27, v94, v6, v27
  v_dot2_f32_bf16 v27, v95, v7, v27
  s_waitcnt vmcnt(5)
  s_cmp_gt_u32 s101, 5
  s_cbranch_scc1 L_cw_95
  s_waitcnt vmcnt(4)
  s_cmp_eq_u32 s101, 5
  s_cbranch_scc1 L_cw_95
  s_waitcnt vmcnt(3)
L_cw_95:
  buffer_load_dwordx4 v[88:91], v1, s[40:43], s64 offen nt
  s_add_u32 s64, s64, 4096
  v_add_u32 v56, 1, v56
  ds_write_b32 v57, v56 offset:29184
  s_waitcnt vmcnt(6)
  v_dot2_f32_bf16 v28, v64, v4, 0
  v_dot2_f32_bf16 v28, v65, v5, v28
  v_dot2_f32_bf16 v28, v66, v6, v28
  v_dot2_f32_bf16 v28, v67, v7, v28
  s_waitcnt vmcnt(5)
  s_cmp_gt_u32 s101, 5
  s_cbranch_scc1 L_cw_96
  s_waitcnt vmcnt(4)
  s_cmp_eq_u32 s101, 5
  s_cbranch_scc1 L_cw_96
  s_waitcnt vmcnt(3)
L_cw_96:
  buffer_load_dwordx4 v[92:95], v1, s[40:43], s64 offen nt
  s_add_u32 s64, s64, 4096
  s_waitcnt vmcnt(6)
  v_dot2_f32_bf16 v29, v68, v4, 0
  v_dot2_f32_bf16 v29, v69, v5, v29
  v_dot2_f32_bf16 v29, v70, v6, v29
  v_dot2_f32_bf16 v29, v71, v7, v29
  s_waitcnt vmcnt(5)
  s_cmp_gt_u32 s101, 5
  s_cbranch_scc1 L_cw_97
  s_waitcnt vmcnt(4)
  s_cmp_eq_u32 s101, 5
  s_cbranch_scc1 L_cw_97
  s_waitcnt vmcnt(3)
L_cw_97:
  s_cmp_eq_u32 s65, 15
  s_cselect_b32 s40, s20, s40
  s_cselect_b32 s41, s21, s41
  s_cselect_b32 s64, s63, s64
  buffer_load_dwordx4 v[64:67], v1, s[40:43], s64 offen nt
  s_add_u32 s64, s64, 4096
  v_add_u32 v56, 1, v56
  ds_write_b32 v57, v56 offset:29184
  s_waitcnt vmcnt(6)
  v_dot2_f32_bf16 v30, v72, v4, 0
  v_dot2_f32_bf16 v30, v73, v5, v30
  v_dot2_f32_bf16 v30, v74, v6, v30
  v_dot2_f32_bf16 v30, v75, v7, v30
  s_waitcnt vmcnt(5)
  s_cmp_gt_u32 s101, 5
  s_cbranch_scc1 L_cw_98
  s_waitcnt vmcnt(4)
  s_cmp_eq_u32 s101, 5
  s_cbranch_scc1 L_cw_98
  s_waitcnt vmcnt(3)
L_cw_98:
  buffer_load_dwordx4 v[68:71], v1, s[40:43], s64 offen nt
  s_add_u32 s64, s64, 4096
  s_waitcnt vmcnt(6)
  v_dot2_f32_bf16 v31, v76, v4, 0
  v_dot2_f32_bf16 v31, v77, v5, v31
  v_dot2_f32_bf16 v31, v78, v6, v31
  v_dot2_f32_bf16 v31, v79, v7, v31
  s_waitcnt vmcnt(5)
  s_cmp_gt_u32 s101, 5
  s_cbranch_scc1 L_cw_99
  s_waitcnt vmcnt(4)
  s_cmp_eq_u32 s101, 5
  s_cbranch_scc1 L_cw_99
  s_waitcnt vmcnt(3)
L_cw_99:
  buffer_load_dwordx4 v[72:75], v1, s[40:43], s64 offen nt
  s_add_u32 s64, s64, 4096
  v_add_u32 v56, 1, v56
  ds_write_b32 v57, v56 offset:29184
  s_waitcnt vmcnt(6)
  v_dot2_f32_bf16 v32, v80, v4, 0
  v_dot2_f32_bf16 v32, v81, v5, v32
  v_dot2_f32_bf16 v32, v82, v6, v32
  v_dot2_f32_bf16 v32, v83, v7, v32
  s_waitcnt vmcnt(5)
  s_cmp_gt_u32 s101, 5
  s_cbranch_scc1 L_cw_100
  s_waitcnt vmcnt(4)
  s_cmp_eq_u32 s101, 5
  s_cbranch_scc1 L_cw_100
  s_waitcnt vmcnt(3)
L_cw_100:
  buffer_load_dwordx4 v[76:79], v1, s[40:43], s64 offen nt
  s_add_u32 s64, s64, 4096
  s_waitcnt vmcnt(6)
  v_dot2_f32_bf16 v33, v84, v4, 0
  v_dot2_f32_bf16 v33, v85, v5, v33
  v_dot2_f32_bf16 v33, v86, v6, v33
  v_dot2_f32_bf16 v33, v87, v7, v33
  s_waitcnt vmcnt(5)
  s_cmp_gt_u32 s101, 5
  s_cbranch_scc1 L_cw_101
  s_waitcnt vmcnt(4)
  s_cmp_eq_u32 s101, 5
  s_cbranch_scc1 L_cw_101
  s_waitcnt vmcnt(3)
L_cw_101:
  buffer_load_dwordx4 v[80:83], v1, s[40:43], s64 offen nt
  s_add_u32 s64, s64, 4096
  v_add_u32 v56, 1, v56
  ds_write_b32 v57, v56 offset:29184
  ds_read_b32 v58, v57 offset:29216
  s_waitcnt vmcnt(6)
  v_dot2_f32_bf16 v34, v88, v4, 0
  v_dot2_f32_bf16 v34, v89, v5, v34
  v_dot2_f32_bf16 v34, v90, v6, v34
  v_dot2_f32_bf16 v34, v91, v7, v34
  s_waitcnt vmcnt(5)
  s_cmp_gt_u32 s101, 5
  s_cbranch_scc1 L_cw_102
  s_waitcnt vmcnt(4)
  s_cmp_eq_u32 s101, 5
  s_cbranch_scc1 L_cw_102
  s_waitcnt vmcnt(3)
L_cw_102:
  buffer_load_dwordx4 v[84:87], v1, s[40:43], s64 offen nt
  s_add_u32 s64, s64, 4096
  s_waitcnt vmcnt(6)
  v_dot2_f32_bf16 v35, v92, v4, 0
  v_dot2_f32_bf16 v35, v93, v5, v35
  v_dot2_f32_bf16 v35, v94, v6, v35
  v_dot2_f32_bf16 v35, v95, v7, v35
  s_waitcnt vmcnt(5)
  s_cmp_gt_u32 s101, 5
  s_cbranch_scc1 L_cw_103
  s_waitcnt vmcnt(4)
  s_cmp_eq_u32 s101, 5
  s_cbranch_scc1 L_cw_103
  s_waitcnt vmcnt(3)
L_cw_103:
  buffer_load_dwordx4 v[88:91], v1, s[40:43], s64 offen nt
  s_add_u32 s64, s64, 4096
  v_add_u32 v56, 1, v56
  ds_write_b32 v57, v56 offset:29184
L_k_join:
  s_waitcnt lgkmcnt(0)
  v_readfirstlane_b32 s101, v58
  v_add_f32_dpp v20, v20, v20 row_ror:8 row_mask:0xf bank_mask:0x3
  v_add_f32_dpp v20, v28, v28 row_ror:8 row_mask:0xf bank_mask:0xc
  v_add_f32_dpp v21, v21, v21 row_ror:8 row_mask:0xf bank_mask:0x3
  v_add_f32_dpp v21, v29, v29 row_ror:8 row_mask:0xf bank_mask:0xc
  v_add_f32_dpp v22, v22, v22 row_ror:8 row_mask:0xf bank_mask:0x3
  v_add_f32_dpp v22, v30, v30 row_ror:8 row_mask:0xf bank_mask:0xc
  v_add_f32_dpp v23, v23, v23 row_ror:8 row_mask:0xf bank_mask:0x3
  v_add_f32_dpp v23, v31, v31 row_ror:8 row_mask:0xf bank_mask:0xc
  v_add_f32_dpp v24, v24, v24 row_ror:8 row_mask:0xf bank_mask:0x3
  v_add_f32_dpp v24, v32, v32 row_ror:8 row_mask:0xf bank_mask:0xc
  v_add_f32_dpp v25, v25, v25 row_ror:8 row_mask:0xf bank_mask:0x3
  v_add_f32_dpp v25, v33, v33 row_ror:8 row_mask:0xf bank_mask:0xc
  v_add_f32_dpp v26, v26, v26 row_ror:8 row_mask:0xf bank_mask:0x3
  v_add_f32_dpp v26, v34, v34 row_ror:8 row_mask:0xf bank_mask:0xc
  v_add_f32_dpp v27, v27, v27 row_ror:8 row_mask:0xf bank_mask:0x3
  v_add_f32_dpp v27, v35, v35 row_ror:8 row_mask:0xf bank_mask:0xc
  v_add_f32_dpp v20, v20, v20 row_shl:4 row_mask:0xf bank_mask:0x5
  v_add_f32_dpp v20, v24, v24 row_shr:4 row_mask:0xf bank_mask:0xa
  v_add_f32_dpp v21, v21, v21 row_shl:4 row_mask:0xf bank_mask:0x5
  v_add_f32_dpp v21, v25, v25 row_shr:4 row_mask:0xf bank_mask:0xa
  v_add_f32_dpp v22, v22, v22 row_shl:4 row_mask:0xf bank_mask:0x5
  v_add_f32_dpp v22, v26, v26 row_shr:4 row_mask:0xf bank_mask:0xa
  v_add_f32_dpp v23, v23, v23 row_shl:4 row_mask:0xf bank_mask:0x5
  v_add_f32_dpp v23, v27, v27 row_shr:4 row_mask:0xf bank_mask:0xa
  v_add_f32_dpp v20, v20, v20 quad_perm:[2,3,0,1] row_mask:0xf bank_mask:0xf
  v_add_f32_dpp v21, v21, v21 quad_perm:[2,3,0,1] row_mask:0xf bank_mask:0xf
  v_add_f32_dpp v22, v22, v22 quad_perm:[2,3,0,1] row_mask:0xf bank_mask:0xf
  v_add_f32_dpp v23, v23, v23 quad_perm:[2,3,0,1] row_mask:0xf bank_mask:0xf
  v_cndmask_b32 v20, v20, v22, s[66:67]
  v_cndmask_b32 v21, v21, v23, s[66:67]
  s_nop 0
  v_add_f32_dpp v20, v20, v20 quad_perm:[1,0,3,2] row_mask:0xf bank_mask:0xf
  v_add_f32_dpp v21, v21, v21 quad_perm:[1,0,3,2] row_mask:0xf bank_mask:0xf
  v_cndmask_b32 v20, v20, v21, s[68:69]
  v_cvt_pk_bf16_f32 v20, v20, v20
  v_lshlrev_b32 v20, 16, v20
  v_mul_f32 v20, s82, v20
  v_cvt_pk_bf16_f32 v20, v20, v20
  v_lshlrev_b32 v20, 16, v20
  v_max_f32 v18, v18, v20
  ds_write_b32 v41, v20 offset:4096
  v_add_u32 v41, 256, v41
  s_add_u32 s65, s65, 1
  s_cmp_lt_u32 s65, 16
  s_cbranch_scc1 L_kloop
  v_subrev_u32 v41, 4096, v41
  ds_read_b32 v44, v41 offset:4096
  v_max_f32_dpp v18, v18, v18 row_ror:8 row_mask:0xf bank_mask:0xf
  s_nop 1
  v_max_f32_dpp v18, v18, v18 row_ror:4 row_mask:0xf bank_mask:0xf
  s_nop 1
  v_max_f32_dpp v18, v18, v18 row_ror:2 row_mask:0xf bank_mask:0xf
  s_nop 1
  v_max_f32_dpp v18, v18, v18 row_ror:1 row_mask:0xf bank_mask:0xf
  v_mov_b32 v46, v18
  s_nop 1
  v_permlane16_swap_b32 v18, v46
  v_max_f32 v18, v18, v46
  v_mov_b32 v46, v18
  s_nop 1
  v_permlane32_swap_b32 v18, v46
  v_max_f32 v18, v18, v46
  v_mul_f32 v18, s83, v18
  v_mov_b32 v46, v18
  v_mov_b32 v47, 1
  s_lshl_b32 s70, s3, 3
  v_mov_b32 v48, s70
  s_waitcnt lgkmcnt(0)
  ds_write_b64 v48, v[46:47] offset:20576
  v_fma_f32 v44, v44, s83, -v18
  v_exp_f32 v44, v44
  v_mov_b32 v8, 0
  v_mov_b32 v9, 0
  v_mov_b32 v10, 0
  v_mov_b32 v11, 0
  v_mov_b32 v12, 0
  v_mov_b32 v13, 0
  v_mov_b32 v14, 0
  v_mov_b32 v15, 0
  v_cvt_pk_bf16_f32 v45, v44, 0
  s_mov_b32 s65, 0
L_vloop:
  v_mov_b32 v16, v45
  v_lshlrev_b32 v17, 16, v45
  v_add_u32 v41, 256, v41
  ds_read_b32 v44, v41 offset:4096
  s_cmp_eq_u32 s65, 8
  s_cbranch_scc1 L_vs_f8
L_vside_done:
  v_mov_b32 v59, s101
  ds_write_b32 v57, v59 offset:29200
  s_waitcnt vmcnt(6)
  v_dot2c_f32_bf16_dpp v8, v16, v64 row_newbcast:0 row_mask:0xf bank_mask:0xf
  v_dot2c_f32_bf16_dpp v9, v17, v64 row_newbcast:0 row_mask:0xf bank_mask:0xf
  v_dot2c_f32_bf16_dpp v10, v16, v65 row_newbcast:0 row_mask:0xf bank_mask:0xf
  v_dot2c_f32_bf16_dpp v11, v17, v65 row_newbcast:0 row_mask:0xf bank_mask:0xf
  v_dot2c_f32_bf16_dpp v12, v16, v66 row_newbcast:0 row_mask:0xf bank_mask:0xf
  v_dot2c_f32_bf16_dpp v13, v17, v66 row_newbcast:0 row_mask:0xf bank_mask:0xf
  v_dot2c_f32_bf16_dpp v14, v16, v67 row_newbcast:0 row_mask:0xf bank_mask:0xf
  v_dot2c_f32_bf16_dpp v15, v17, v67 row_newbcast:0 row_mask:0xf bank_mask:0xf
  s_waitcnt vmcnt(5)
  s_cmp_gt_u32 s101, 5
  s_cbranch_scc1 L_cw_104
  s_waitcnt vmcnt(4)
  s_cmp_eq_u32 s101, 5
  s_cbranch_scc1 L_cw_104
  s_waitcnt vmcnt(3)
L_cw_104:
  buffer_load_dwordx4 v[92:95], v1, s[40:43], s64 offen nt
  s_add_u32 s64, s64, 4096
  s_waitcnt vmcnt(6)
  v_dot2c_f32_bf16_dpp v8, v16, v68 row_newbcast:1 row_mask:0xf bank_mask:0xf
  v_dot2c_f32_bf16_dpp v9, v17, v68 row_newbcast:1 row_mask:0xf bank_mask:0xf
  v_dot2c_f32_bf16_dpp v10, v16, v69 row_newbcast:1 row_mask:0xf bank_mask:0xf
  v_dot2c_f32_bf16_dpp v11, v17, v69 row_newbcast:1 row_mask:0xf bank_mask:0xf
  v_dot2c_f32_bf16_dpp v12, v16, v70 row_newbcast:1 row_mask:0xf bank_mask:0xf
  v_dot2c_f32_bf16_dpp v13, v17, v70 row_newbcast:1 row_mask:0xf bank_mask:0xf
  v_dot2c_f32_bf16_dpp v14, v16, v71 row_newbcast:1 row_mask:0xf bank_mask:0xf
  v_dot2c_f32_bf16_dpp v15, v17, v71 row_newbcast:1 row_mask:0xf bank_mask:0xf
  s_waitcnt vmcnt(5)
  s_cmp_gt_u32 s101, 5
  s_cbranch_scc1 L_cw_105
  s_waitcnt vmcnt(4)
  s_cmp_eq_u32 s101, 5
  s_cbranch_scc1 L_cw_105
  s_waitcnt vmcnt(3)
L_cw_105:
  buffer_load_dwordx4 v[64:67], v1, s[40:43], s64 offen nt
  s_add_u32 s64, s64, 4096
  v_add_u32 v56, 1, v56
  ds_write_b32 v57, v56 offset:29184
  s_waitcnt vmcnt(6)
  v_dot2c_f32_bf16_dpp v8, v16, v72 row_newbcast:2 row_mask:0xf bank_mask:0xf
  v_dot2c_f32_bf16_dpp v9, v17, v72 row_newbcast:2 row_mask:0xf bank_mask:0xf
  v_dot2c_f32_bf16_dpp v10, v16, v73 row_newbcast:2 row_mask:0xf bank_mask:0xf
  v_dot2c_f32_bf16_dpp v11, v17, v73 row_newbcast:2 row_mask:0xf bank_mask:0xf
  v_dot2c_f32_bf16_dpp v12, v16, v74 row_newbcast:2 row_mask:0xf bank_mask:0xf
  v_dot2c_f32_bf16_dpp v13, v17, v74 row_newbcast:2 row_mask:0xf bank_mask:0xf
  v_dot2c_f32_bf16_dpp v14, v16, v75 row_newbcast:2 row_mask:0xf bank_mask:0xf
  v_dot2c_f32_bf16_dpp v15, v17, v75 row_newbcast:2 row_mask:0xf bank_mask:0xf
  s_waitcnt vmcnt(5)
  s_cmp_gt_u32 s101, 5
  s_cbranch_scc1 L_cw_106
  s_waitcnt vmcnt(4)
  s_cmp_eq_u32 s101, 5
  s_cbranch_scc1 L_cw_106
  s_waitcnt vmcnt(3)
L_cw_106:
  buffer_load_dwordx4 v[68:71], v1, s[40:43], s64 offen nt
  s_add_u32 s64, s64, 4096
  s_waitcnt vmcnt(6)
  v_dot2c_f32_bf16_dpp v8, v16, v76 row_newbcast:3 row_mask:0xf bank_mask:0xf
  v_dot2c_f32_bf16_dpp v9, v17, v76 row_newbcast:3 row_mask:0xf bank_mask:0xf
  v_dot2c_f32_bf16_dpp v10, v16, v77 row_newbcast:3 row_mask:0xf bank_mask:0xf
  v_dot2c_f32_bf16_dpp v11, v17, v77 row_newbcast:3 row_mask:0xf bank_mask:0xf
  v_dot2c_f32_bf16_dpp v12, v16, v78 row_newbcast:3 row_mask:0xf bank_mask:0xf
  v_dot2c_f32_bf16_dpp v13, v17, v78 row_newbcast:3 row_mask:0xf bank_mask:0xf
  v_dot2c_f32_bf16_dpp v14, v16, v79 row_newbcast:3 row_mask:0xf bank_mask:0xf
  v_dot2c_f32_bf16_dpp v15, v17, v79 row_newbcast:3 row_mask:0xf bank_mask:0xf
  s_waitcnt vmcnt(5)
  s_cmp_gt_u32 s101, 5
  s_cbranch_scc1 L_cw_107
  s_waitcnt vmcnt(4)
  s_cmp_eq_u32 s101, 5
  s_cbranch_scc1 L_cw_107
  s_waitcnt vmcnt(3)
L_cw_107:
  buffer_load_dwordx4 v[72:75], v1, s[40:43], s64 offen nt
  s_add_u32 s64, s64, 4096
  v_add_u32 v56, 1, v56
  ds_write_b32 v57, v56 offset:29184
  s_waitcnt vmcnt(6)
  v_dot2c_f32_bf16_dpp v8, v16, v80 row_newbcast:4 row_mask:0xf bank_mask:0xf
  v_dot2c_f32_bf16_dpp v9, v17, v80 row_newbcast:4 row_mask:0xf bank_mask:0xf
  v_dot2c_f32_bf16_dpp v10, v16, v81 row_newbcast:4 row_mask:0xf bank_mask:0xf
  v_dot2c_f32_bf16_dpp v11, v17, v81 row_newbcast:4 row_mask:0xf bank_mask:0xf
  v_dot2c_f32_bf16_dpp v12, v16, v82 row_newbcast:4 row_mask:0xf bank_mask:0xf
  v_dot2c_f32_bf16_dpp v13, v17, v82 row_newbcast:4 row_mask:0xf bank_mask:0xf
  v_dot2c_f32_bf16_dpp v14, v16, v83 row_newbcast:4 row_mask:0xf bank_mask:0xf
  v_dot2c_f32_bf16_dpp v15, v17, v83 row_newbcast:4 row_mask:0xf bank_mask:0xf
  s_waitcnt vmcnt(5)
  s_cmp_gt_u32 s101, 5
  s_cbranch_scc1 L_cw_108
  s_waitcnt vmcnt(4)
  s_cmp_eq_u32 s101, 5
  s_cbranch_scc1 L_cw_108
  s_waitcnt vmcnt(3)
L_cw_108:
  buffer_load_dwordx4 v[76:79], v1, s[40:43], s64 offen nt
  s_add_u32 s64, s64, 4096
  s_waitcnt vmcnt(6)
  v_dot2c_f32_bf16_dpp v8, v16, v84 row_newbcast:5 row_mask:0xf bank_mask:0xf
  v_dot2c_f32_bf16_dpp v9, v17, v84 row_newbcast:5 row_mask:0xf bank_mask:0xf
  v_dot2c_f32_bf16_dpp v10, v16, v85 row_newbcast:5 row_mask:0xf bank_mask:0xf
  v_dot2c_f32_bf16_dpp v11, v17, v85 row_newbcast:5 row_mask:0xf bank_mask:0xf
  v_dot2c_f32_bf16_dpp v12, v16, v86 row_newbcast:5 row_mask:0xf bank_mask:0xf
  v_dot2c_f32_bf16_dpp v13, v17, v86 row_newbcast:5 row_mask:0xf bank_mask:0xf
  v_dot2c_f32_bf16_dpp v14, v16, v87 row_newbcast:5 row_mask:0xf bank_mask:0xf
  v_dot2c_f32_bf16_dpp v15, v17, v87 row_newbcast:5 row_mask:0xf bank_mask:0xf
  s_waitcnt vmcnt(5)
  s_cmp_gt_u32 s101, 5
  s_cbranch_scc1 L_cw_109
  s_waitcnt vmcnt(4)
  s_cmp_eq_u32 s101, 5
  s_cbranch_scc1 L_cw_109
  s_waitcnt vmcnt(3)
L_cw_109:
  buffer_load_dwordx4 v[80:83], v1, s[40:43], s64 offen nt
  s_add_u32 s64, s64, 4096
  s_waitcnt lgkmcnt(0)
  v_fma_f32 v44, v44, s83, -v18
  v_exp_f32 v44, v44
  v_add_u32 v56, 1, v56
  ds_write_b32 v57, v56 offset:29184
  s_waitcnt vmcnt(6)
  v_dot2c_f32_bf16_dpp v8, v16, v88 row_newbcast:6 row_mask:0xf bank_mask:0xf
  v_dot2c_f32_bf16_dpp v9, v17, v88 row_newbcast:6 row_mask:0xf bank_mask:0xf
  v_dot2c_f32_bf16_dpp v10, v16, v89 row_newbcast:6 row_mask:0xf bank_mask:0xf
  v_dot2c_f32_bf16_dpp v11, v17, v89 row_newbcast:6 row_mask:0xf bank_mask:0xf
  v_dot2c_f32_bf16_dpp v12, v16, v90 row_newbcast:6 row_mask:0xf bank_mask:0xf
  v_dot2c_f32_bf16_dpp v13, v17, v90 row_newbcast:6 row_mask:0xf bank_mask:0xf
  v_dot2c_f32_bf16_dpp v14, v16, v91 row_newbcast:6 row_mask:0xf bank_mask:0xf
  v_dot2c_f32_bf16_dpp v15, v17, v91 row_newbcast:6 row_mask:0xf bank_mask:0xf
  s_waitcnt vmcnt(5)
  s_cmp_gt_u32 s101, 5
  s_cbranch_scc1 L_cw_110
  s_waitcnt vmcnt(4)
  s_cmp_eq_u32 s101, 5
  s_cbranch_scc1 L_cw_110
  s_waitcnt vmcnt(3)
L_cw_110:
  buffer_load_dwordx4 v[84:87], v1, s[40:43], s64 offen nt
  s_add_u32 s64, s64, 4096
  s_waitcnt vmcnt(6)
  v_dot2c_f32_bf16_dpp v8, v16, v92 row_newbcast:7 row_mask:0xf bank_mask:0xf
  v_dot2c_f32_bf16_dpp v9, v17, v92 row_newbcast:7 row_mask:0xf bank_mask:0xf
  v_dot2c_f32_bf16_dpp v10, v16, v93 row_newbcast:7 row_mask:0xf bank_mask:0xf
  v_dot2c_f32_bf16_dpp v11, v17, v93 row_newbcast:7 row_mask:0xf bank_mask:0xf
  v_dot2c_f32_bf16_dpp v12, v16, v94 row_newbcast:7 row_mask:0xf bank_mask:0xf
  v_dot2c_f32_bf16_dpp v13, v17, v94 row_newbcast:7 row_mask:0xf bank_mask:0xf
  v_dot2c_f32_bf16_dpp v14, v16, v95 row_newbcast:7 row_mask:0xf bank_mask:0xf
  v_dot2c_f32_bf16_dpp v15, v17, v95 row_newbcast:7 row_mask:0xf bank_mask:0xf
  s_waitcnt vmcnt(5)
  s_cmp_gt_u32 s101, 5
  s_cbranch_scc1 L_cw_111
  s_waitcnt vmcnt(4)
  s_cmp_eq_u32 s101, 5
  s_cbranch_scc1 L_cw_111
  s_waitcnt vmcnt(3)
L_cw_111:
  buffer_load_dwordx4 v[88:91], v1, s[40:43], s64 offen nt
  s_add_u32 s64, s64, 4096
  v_cvt_pk_bf16_f32 v45, v44, 0
  v_add_u32 v56, 1, v56
  ds_write_b32 v57, v56 offset:29184
  s_waitcnt vmcnt(6)
  v_dot2c_f32_bf16_dpp v8, v16, v64 row_newbcast:8 row_mask:0xf bank_mask:0xf
  v_dot2c_f32_bf16_dpp v9, v17, v64 row_newbcast:8 row_mask:0xf bank_mask:0xf
  v_dot2c_f32_bf16_dpp v10, v16, v65 row_newbcast:8 row_mask:0xf bank_mask:0xf
  v_dot2c_f32_bf16_dpp v11, v17, v65 row_newbcast:8 row_mask:0xf bank_mask:0xf
  v_dot2c_f32_bf16_dpp v12, v16, v66 row_newbcast:8 row_mask:0xf bank_mask:0xf
  v_dot2c_f32_bf16_dpp v13, v17, v66 row_newbcast:8 row_mask:0xf bank_mask:0xf
  v_dot2c_f32_bf16_dpp v14, v16, v67 row_newbcast:8 row_mask:0xf bank_mask:0xf
  v_dot2c_f32_bf16_dpp v15, v17, v67 row_newbcast:8 row_mask:0xf bank_mask:0xf
  s_waitcnt vmcnt(5)
  s_cmp_gt_u32 s101, 5
  s_cbranch_scc1 L_cw_112
  s_waitcnt vmcnt(4)
  s_cmp_eq_u32 s101, 5
  s_cbranch_scc1 L_cw_112
  s_waitcnt vmcnt(3)
L_cw_112:
  buffer_load_dwordx4 v[92:95], v1, s[40:43], s64 offen nt
  s_add_u32 s64, s64, 4096
  s_waitcnt vmcnt(6)
  v_dot2c_f32_bf16_dpp v8, v16, v68 row_newbcast:9 row_mask:0xf bank_mask:0xf
  v_dot2c_f32_bf16_dpp v9, v17, v68 row_newbcast:9 row_mask:0xf bank_mask:0xf
  v_dot2c_f32_bf16_dpp v10, v16, v69 row_newbcast:9 row_mask:0xf bank_mask:0xf
  v_dot2c_f32_bf16_dpp v11, v17, v69 row_newbcast:9 row_mask:0xf bank_mask:0xf
  v_dot2c_f32_bf16_dpp v12, v16, v70 row_newbcast:9 row_mask:0xf bank_mask:0xf
  v_dot2c_f32_bf16_dpp v13, v17, v70 row_newbcast:9 row_mask:0xf bank_mask:0xf
  v_dot2c_f32_bf16_dpp v14, v16, v71 row_newbcast:9 row_mask:0xf bank_mask:0xf
  v_dot2c_f32_bf16_dpp v15, v17, v71 row_newbcast:9 row_mask:0xf bank_mask:0xf
  s_waitcnt vmcnt(5)
  s_cmp_gt_u32 s101, 5
  s_cbranch_scc1 L_cw_113
  s_waitcnt vmcnt(4)
  s_cmp_eq_u32 s101, 5
  s_cbranch_scc1 L_cw_113
  s_waitcnt vmcnt(3)
L_cw_113:
  buffer_load_dwordx4 v[64:67], v1, s[40:43], s64 offen nt
  s_add_u32 s64, s64, 4096
  v_add_u32 v56, 1, v56
  ds_write_b32 v57, v56 offset:29184
  s_waitcnt vmcnt(6)
  v_dot2c_f32_bf16_dpp v8, v16, v72 row_newbcast:10 row_mask:0xf bank_mask:0xf
  v_dot2c_f32_bf16_dpp v9, v17, v72 row_newbcast:10 row_mask:0xf bank_mask:0xf
  v_dot2c_f32_bf16_dpp v10, v16, v73 row_newbcast:10 row_mask:0xf bank_mask:0xf
  v_dot2c_f32_bf16_dpp v11, v17, v73 row_newbcast:10 row_mask:0xf bank_mask:0xf
  v_dot2c_f32_bf16_dpp v12, v16, v74 row_newbcast:10 row_mask:0xf bank_mask:0xf
  v_dot2c_f32_bf16_dpp v13, v17, v74 row_newbcast:10 row_mask:0xf bank_mask:0xf
  v_dot2c_f32_bf16_dpp v14, v16, v75 row_newbcast:10 row_mask:0xf bank_mask:0xf
  v_dot2c_f32_bf16_dpp v15, v17, v75 row_newbcast:10 row_mask:0xf bank_mask:0xf
  s_waitcnt vmcnt(5)
  s_cmp_gt_u32 s101, 5
  s_cbranch_scc1 L_cw_114
  s_waitcnt vmcnt(4)
  s_cmp_eq_u32 s101, 5
  s_cbranch_scc1 L_cw_114
  s_waitcnt vmcnt(3)
L_cw_114:
  buffer_load_dwordx4 v[68:71], v1, s[40:43], s64 offen nt
  s_add_u32 s64, s64, 4096
  s_waitcnt vmcnt(6)
  v_dot2c_f32_bf16_dpp v8, v16, v76 row_newbcast:11 row_mask:0xf bank_mask:0xf
  v_dot2c_f32_bf16_dpp v9, v17, v76 row_newbcast:11 row_mask:0xf bank_mask:0xf
  v_dot2c_f32_bf16_dpp v10, v16, v77 row_newbcast:11 row_mask:0xf bank_mask:0xf
  v_dot2c_f32_bf16_dpp v11, v17, v77 row_newbcast:11 row_mask:0xf bank_mask:0xf
  v_dot2c_f32_bf16_dpp v12, v16, v78 row_newbcast:11 row_mask:0xf bank_mask:0xf
  v_dot2c_f32_bf16_dpp v13, v17, v78 row_newbcast:11 row_mask:0xf bank_mask:0xf
  v_dot2c_f32_bf16_dpp v14, v16, v79 row_newbcast:11 row_mask:0xf bank_mask:0xf
  v_dot2c_f32_bf16_dpp v15, v17, v79 row_newbcast:11 row_mask:0xf bank_mask:0xf
  s_waitcnt vmcnt(5)
  s_cmp_gt_u32 s101, 5
  s_cbranch_scc1 L_cw_115
  s_waitcnt vmcnt(4)
  s_cmp_eq_u32 s101, 5
  s_cbranch_scc1 L_cw_115
  s_waitcnt vmcnt(3)
L_cw_115:
  buffer_load_dwordx4 v[72:75], v1, s[40:43], s64 offen nt
  s_add_u32 s64, s64, 4096
  v_add_u32 v56, 1, v56
  ds_write_b32 v57, v56 offset:29184
  s_waitcnt vmcnt(6)
  v_dot2c_f32_bf16_dpp v8, v16, v80 row_newbcast:12 row_mask:0xf bank_mask:0xf
  v_dot2c_f32_bf16_dpp v9, v17, v80 row_newbcast:12 row_mask:0xf bank_mask:0xf
  v_dot2c_f32_bf16_dpp v10, v16, v81 row_newbcast:12 row_mask:0xf bank_mask:0xf
  v_dot2c_f32_bf16_dpp v11, v17, v81 row_newbcast:12 row_mask:0xf bank_mask:0xf
  v_dot2c_f32_bf16_dpp v12, v16, v82 row_newbcast:12 row_mask:0xf bank_mask:0xf
  v_dot2c_f32_bf16_dpp v13, v17, v82 row_newbcast:12 row_mask:0xf bank_mask:0xf
  v_dot2c_f32_bf16_dpp v14, v16, v83 row_newbcast:12 row_mask:0xf bank_mask:0xf
  v_dot2c_f32_bf16_dpp v15, v17, v83 row_newbcast:12 row_mask:0xf bank_mask:0xf
  s_waitcnt vmcnt(5)
  s_cmp_gt_u32 s101, 5
  s_cbranch_scc1 L_cw_116
  s_waitcnt vmcnt(4)
  s_cmp_eq_u32 s101, 5
  s_cbranch_scc1 L_cw_116
  s_waitcnt vmcnt(3)
L_cw_116:
  buffer_load_dwordx4 v[76:79], v1, s[40:43], s64 offen nt
  s_add_u32 s64, s64, 4096
  s_waitcnt vmcnt(6)
  v_dot2c_f32_bf16_dpp v8, v16, v84 row_newbcast:13 row_mask:0xf bank_mask:0xf
  v_dot2c_f32_bf16_dpp v9, v17, v84 row_newbcast:13 row_mask:0xf bank_mask:0xf
  v_dot2c_f32_bf16_dpp v10, v16, v85 row_newbcast:13 row_mask:0xf bank_mask:0xf
  v_dot2c_f32_bf16_dpp v11, v17, v85 row_newbcast:13 row_mask:0xf bank_mask:0xf
  v_dot2c_f32_bf16_dpp v12, v16, v86 row_newbcast:13 row_mask:0xf bank_mask:0xf
  v_dot2c_f32_bf16_dpp v13, v17, v86 row_newbcast:13 row_mask:0xf bank_mask:0xf
  v_dot2c_f32_bf16_dpp v14, v16, v87 row_newbcast:13 row_mask:0xf bank_mask:0xf
  v_dot2c_f32_bf16_dpp v15, v17, v87 row_newbcast:13 row_mask:0xf bank_mask:0xf
  s_waitcnt vmcnt(5)
  s_cmp_gt_u32 s101, 5
  s_cbranch_scc1 L_cw_117
  s_waitcnt vmcnt(4)
  s_cmp_eq_u32 s101, 5
  s_cbranch_scc1 L_cw_117
  s_waitcnt vmcnt(3)
L_cw_117:
  buffer_load_dwordx4 v[80:83], v1, s[40:43], s64 offen nt
  s_add_u32 s64, s64, 4096
  v_add_u32 v56, 1, v56
  ds_write_b32 v57, v56 offset:29184
  ds_read_b32 v58, v57 offset:29216
  s_waitcnt vmcnt(6)
  v_dot2c_f32_bf16_dpp v8, v16, v88 row_newbcast:14 row_mask:0xf bank_mask:0xf
  v_dot2c_f32_bf16_dpp v9, v17, v88 row_newbcast:14 row_mask:0xf bank_mask:0xf
  v_dot2c_f32_bf16_dpp v10, v16, v89 row_newbcast:14 row_mask:0xf bank_mask:0xf
  v_dot2c_f32_bf16_dpp v11, v17, v89 row_newbcast:14 row_mask:0xf bank_mask:0xf
  v_dot2c_f32_bf16_dpp v12, v16, v90 row_newbcast:14 row_mask:0xf bank_mask:0xf
  v_dot2c_f32_bf16_dpp v13, v17, v90 row_newbcast:14 row_mask:0xf bank_mask:0xf
  v_dot2c_f32_bf16_dpp v14, v16, v91 row_newbcast:14 row_mask:0xf bank_mask:0xf
  v_dot2c_f32_bf16_dpp v15, v17, v91 row_newbcast:14 row_mask:0xf bank_mask:0xf
  s_waitcnt vmcnt(5)
  s_cmp_gt_u32 s101, 5
  s_cbranch_scc1 L_cw_118
  s_waitcnt vmcnt(4)
  s_cmp_eq_u32 s101, 5
  s_cbranch_scc1 L_cw_118
  s_waitcnt vmcnt(3)
L_cw_118:
  buffer_load_dwordx4 v[84:87], v1, s[40:43], s64 offen nt
  s_add_u32 s64, s64, 4096
  s_waitcnt vmcnt(6)
  v_dot2c_f32_bf16_dpp v8, v16, v92 row_newbcast:15 row_mask:0xf bank_mask:0xf
  v_dot2c_f32_bf16_dpp v9, v17, v92 row_newbcast:15 row_mask:0xf bank_mask:0xf
  v_dot2c_f32_bf16_dpp v10, v16, v93 row_newbcast:15 row_mask:0xf bank_mask:0xf
  v_dot2c_f32_bf16_dpp v11, v17, v93 row_newbcast:15 row_mask:0xf bank_mask:0xf
  v_dot2c_f32_bf16_dpp v12, v16, v94 row_newbcast:15 row_mask:0xf bank_mask:0xf
  v_dot2c_f32_bf16_dpp v13, v17, v94 row_newbcast:15 row_mask:0xf bank_mask:0xf
  v_dot2c_f32_bf16_dpp v14, v16, v95 row_newbcast:15 row_mask:0xf bank_mask:0xf
  v_dot2c_f32_bf16_dpp v15, v17, v95 row_newbcast:15 row_mask:0xf bank_mask:0xf
  s_waitcnt vmcnt(5)
  s_cmp_gt_u32 s101, 5
  s_cbranch_scc1 L_cw_119
  s_waitcnt vmcnt(4)
  s_cmp_eq_u32 s101, 5
  s_cbranch_scc1 L_cw_119
  s_waitcnt vmcnt(3)
L_cw_119:
  buffer_load_dwordx4 v[88:91], v1, s[40:43], s64 offen nt
  s_add_u32 s64, s64, 4096
  v_add_u32 v56, 1, v56
  ds_write_b32 v57, v56 offset:29184
L_v_join:
  s_waitcnt lgkmcnt(0)
  v_readfirstlane_b32 s101, v58
  s_add_u32 s65, s65, 1
  s_cmp_lt_u32 s65, 15
  s_cbranch_scc1 L_vloop
  v_mov_b32 v16, v45
  v_lshlrev_b32 v17, 16, v45
  s_lshl_b32 s70, s3, 3
  v_mov_b32 v48, s70
  s_waitcnt vmcnt(6)
  v_dot2c_f32_bf16_dpp v8, v16, v64 row_newbcast:0 row_mask:0xf bank_mask:0xf
  v_dot2c_f32_bf16_dpp v9, v17, v64 row_newbcast:0 row_mask:0xf bank_mask:0xf
  v_dot2c_f32_bf16_dpp v10, v16, v65 row_newbcast:0 row_mask:0xf bank_mask:0xf
  v_dot2c_f32_bf16_dpp v11, v17, v65 row_newbcast:0 row_mask:0xf bank_mask:0xf
  v_dot2c_f32_bf16_dpp v12, v16, v66 row_newbcast:0 row_mask:0xf bank_mask:0xf
  v_dot2c_f32_bf16_dpp v13, v17, v66 row_newbcast:0 row_mask:0xf bank_mask:0xf
  v_dot2c_f32_bf16_dpp v14, v16, v67 row_newbcast:0 row_mask:0xf bank_mask:0xf
  v_dot2c_f32_bf16_dpp v15, v17, v67 row_newbcast:0 row_mask:0xf bank_mask:0xf
  s_waitcnt vmcnt(6)
  s_cmp_gt_u32 s101, 5
  s_cbranch_scc1 L_cw_120
  s_waitcnt vmcnt(5)
  s_cmp_eq_u32 s101, 5
  s_cbranch_scc1 L_cw_120
  s_waitcnt vmcnt(4)
L_cw_120:
  buffer_load_dwordx4 v[92:95], v1, s[40:43], s64 offen nt
  s_add_u32 s64, s64, 4096
  s_waitcnt vmcnt(6)
  v_dot2c_f32_bf16_dpp v8, v16, v68 row_newbcast:1 row_mask:0xf bank_mask:0xf
  v_dot2c_f32_bf16_dpp v9, v17, v68 row_newbcast:1 row_mask:0xf bank_mask:0xf
  v_dot2c_f32_bf16_dpp v10, v16, v69 row_newbcast:1 row_mask:0xf bank_mask:0xf
  v_dot2c_f32_bf16_dpp v11, v17, v69 row_newbcast:1 row_mask:0xf bank_mask:0xf
  v_dot2c_f32_bf16_dpp v12, v16, v70 row_newbcast:1 row_mask:0xf bank_mask:0xf
  v_dot2c_f32_bf16_dpp v13, v17, v70 row_newbcast:1 row_mask:0xf bank_mask:0xf
  v_dot2c_f32_bf16_dpp v14, v16, v71 row_newbcast:1 row_mask:0xf bank_mask:0xf
  v_dot2c_f32_bf16_dpp v15, v17, v71 row_newbcast:1 row_mask:0xf bank_mask:0xf
  s_waitcnt vmcnt(6)
  s_cmp_gt_u32 s101, 5
  s_cbranch_scc1 L_cw_121
  s_waitcnt vmcnt(5)
  s_cmp_eq_u32 s101, 5
  s_cbranch_scc1 L_cw_121
  s_waitcnt vmcnt(4)
L_cw_121:
  buffer_load_dwordx4 v[64:67], v1, s[40:43], s64 offen nt
  s_add_u32 s64, s64, 4096
  v_add_u32 v56, 1, v56
  ds_write_b32 v57, v56 offset:29184
  s_waitcnt vmcnt(6)
  v_dot2c_f32_bf16_dpp v8, v16, v72 row_newbcast:2 row_mask:0xf bank_mask:0xf
  v_dot2c_f32_bf16_dpp v9, v17, v72 row_newbcast:2 row_mask:0xf bank_mask:0xf
  v_dot2c_f32_bf16_dpp v10, v16, v73 row_newbcast:2 row_mask:0xf bank_mask:0xf
  v_dot2c_f32_bf16_dpp v11, v17, v73 row_newbcast:2 row_mask:0xf bank_mask:0xf
  v_dot2c_f32_bf16_dpp v12, v16, v74 row_newbcast:2 row_mask:0xf bank_mask:0xf
  v_dot2c_f32_bf16_dpp v13, v17, v74 row_newbcast:2 row_mask:0xf bank_mask:0xf
  v_dot2c_f32_bf16_dpp v14, v16, v75 row_newbcast:2 row_mask:0xf bank_mask:0xf
  v_dot2c_f32_bf16_dpp v15, v17, v75 row_newbcast:2 row_mask:0xf bank_mask:0xf
  s_waitcnt vmcnt(6)
  s_cmp_gt_u32 s101, 5
  s_cbranch_scc1 L_cw_122
  s_waitcnt vmcnt(5)
  s_cmp_eq_u32 s101, 5
  s_cbranch_scc1 L_cw_122
  s_waitcnt vmcnt(4)
L_cw_122:
  buffer_load_dwordx4 v[68:71], v1, s[40:43], s64 offen nt
  s_add_u32 s64, s64, 4096
  s_waitcnt vmcnt(6)
  v_dot2c_f32_bf16_dpp v8, v16, v76 row_newbcast:3 row_mask:0xf bank_mask:0xf
  v_dot2c_f32_bf16_dpp v9, v17, v76 row_newbcast:3 row_mask:0xf bank_mask:0xf
  v_dot2c_f32_bf16_dpp v10, v16, v77 row_newbcast:3 row_mask:0xf bank_mask:0xf
  v_dot2c_f32_bf16_dpp v11, v17, v77 row_newbcast:3 row_mask:0xf bank_mask:0xf
  v_dot2c_f32_bf16_dpp v12, v16, v78 row_newbcast:3 row_mask:0xf bank_mask:0xf
  v_dot2c_f32_bf16_dpp v13, v17, v78 row_newbcast:3 row_mask:0xf bank_mask:0xf
  v_dot2c_f32_bf16_dpp v14, v16, v79 row_newbcast:3 row_mask:0xf bank_mask:0xf
  v_dot2c_f32_bf16_dpp v15, v17, v79 row_newbcast:3 row_mask:0xf bank_mask:0xf
  s_waitcnt vmcnt(6)
  s_cmp_gt_u32 s101, 5
  s_cbranch_scc1 L_cw_123
  s_waitcnt vmcnt(5)
  s_cmp_eq_u32 s101, 5
  s_cbranch_scc1 L_cw_123
  s_waitcnt vmcnt(4)
L_cw_123:
  buffer_load_dwordx4 v[72:75], v1, s[40:43], s64 offen nt
  s_add_u32 s64, s64, 4096
  v_add_u32 v56, 1, v56
  ds_write_b32 v57, v56 offset:29184
  s_waitcnt vmcnt(6)
  v_dot2c_f32_bf16_dpp v8, v16, v80 row_newbcast:4 row_mask:0xf bank_mask:0xf
  v_dot2c_f32_bf16_dpp v9, v17, v80 row_newbcast:4 row_mask:0xf bank_mask:0xf
  v_dot2c_f32_bf16_dpp v10, v16, v81 row_newbcast:4 row_mask:0xf bank_mask:0xf
  v_dot2c_f32_bf16_dpp v11, v17, v81 row_newbcast:4 row_mask:0xf bank_mask:0xf
  v_dot2c_f32_bf16_dpp v12, v16, v82 row_newbcast:4 row_mask:0xf bank_mask:0xf
  v_dot2c_f32_bf16_dpp v13, v17, v82 row_newbcast:4 row_mask:0xf bank_mask:0xf
  v_dot2c_f32_bf16_dpp v14, v16, v83 row_newbcast:4 row_mask:0xf bank_mask:0xf
  v_dot2c_f32_bf16_dpp v15, v17, v83 row_newbcast:4 row_mask:0xf bank_mask:0xf
  s_waitcnt vmcnt(6)
  s_cmp_gt_u32 s101, 5
  s_cbranch_scc1 L_cw_124
  s_waitcnt vmcnt(5)
  s_cmp_eq_u32 s101, 5
  s_cbranch_scc1 L_cw_124
  s_waitcnt vmcnt(4)
L_cw_124:
  buffer_load_dwordx4 v[76:79], v1, s[40:43], s64 offen nt
  s_add_u32 s64, s64, 4096
  s_waitcnt vmcnt(6)
  v_dot2c_f32_bf16_dpp v8, v16, v84 row_newbcast:5 row_mask:0xf bank_mask:0xf
  v_dot2c_f32_bf16_dpp v9, v17, v84 row_newbcast:5 row_mask:0xf bank_mask:0xf
  v_dot2c_f32_bf16_dpp v10, v16, v85 row_newbcast:5 row_mask:0xf bank_mask:0xf
  v_dot2c_f32_bf16_dpp v11, v17, v85 row_newbcast:5 row_mask:0xf bank_mask:0xf
  v_dot2c_f32_bf16_dpp v12, v16, v86 row_newbcast:5 row_mask:0xf bank_mask:0xf
  v_dot2c_f32_bf16_dpp v13, v17, v86 row_newbcast:5 row_mask:0xf bank_mask:0xf
  v_dot2c_f32_bf16_dpp v14, v16, v87 row_newbcast:5 row_mask:0xf bank_mask:0xf
  v_dot2c_f32_bf16_dpp v15, v17, v87 row_newbcast:5 row_mask:0xf bank_mask:0xf
  s_waitcnt vmcnt(6)
  s_cmp_gt_u32 s101, 5
  s_cbranch_scc1 L_cw_125
  s_waitcnt vmcnt(5)
  s_cmp_eq_u32 s101, 5
  s_cbranch_scc1 L_cw_125
  s_waitcnt vmcnt(4)
L_cw_125:
  buffer_load_dwordx4 v[80:83], v1, s[40:43], s64 offen nt
  s_add_u32 s64, s64, 4096
  v_add_u32 v56, 1, v56
  ds_write_b32 v57, v56 offset:29184
  s_waitcnt vmcnt(6)
  v_dot2c_f32_bf16_dpp v8, v16, v88 row_newbcast:6 row_mask:0xf bank_mask:0xf
  v_dot2c_f32_bf16_dpp v9, v17, v88 row_newbcast:6 row_mask:0xf bank_mask:0xf
  v_dot2c_f32_bf16_dpp v10, v16, v89 row_newbcast:6 row_mask:0xf bank_mask:0xf
  v_dot2c_f32_bf16_dpp v11, v17, v89 row_newbcast:6 row_mask:0xf bank_mask:0xf
  v_dot2c_f32_bf16_dpp v12, v16, v90 row_newbcast:6 row_mask:0xf bank_mask:0xf
  v_dot2c_f32_bf16_dpp v13, v17, v90 row_newbcast:6 row_mask:0xf bank_mask:0xf
  v_dot2c_f32_bf16_dpp v14, v16, v91 row_newbcast:6 row_mask:0xf bank_mask:0xf
  v_dot2c_f32_bf16_dpp v15, v17, v91 row_newbcast:6 row_mask:0xf bank_mask:0xf
  s_waitcnt vmcnt(6)
  s_cmp_gt_u32 s101, 5
  s_cbranch_scc1 L_cw_126
  s_waitcnt vmcnt(5)
  s_cmp_eq_u32 s101, 5
  s_cbranch_scc1 L_cw_126
  s_waitcnt vmcnt(4)
L_cw_126:
  buffer_load_dwordx4 v[84:87], v1, s[40:43], s64 offen nt
  s_add_u32 s64, s64, 4096
  s_waitcnt vmcnt(6)
  v_dot2c_f32_bf16_dpp v8, v16, v92 row_newbcast:7 row_mask:0xf bank_mask:0xf
  v_dot2c_f32_bf16_dpp v9, v17, v92 row_newbcast:7 row_mask:0xf bank_mask:0xf
  v_dot2c_f32_bf16_dpp v10, v16, v93 row_newbcast:7 row_mask:0xf bank_mask:0xf
  v_dot2c_f32_bf16_dpp v11, v17, v93 row_newbcast:7 row_mask:0xf bank_mask:0xf
  v_dot2c_f32_bf16_dpp v12, v16, v94 row_newbcast:7 row_mask:0xf bank_mask:0xf
  v_dot2c_f32_bf16_dpp v13, v17, v94 row_newbcast:7 row_mask:0xf bank_mask:0xf
  v_dot2c_f32_bf16_dpp v14, v16, v95 row_newbcast:7 row_mask:0xf bank_mask:0xf
  v_dot2c_f32_bf16_dpp v15, v17, v95 row_newbcast:7 row_mask:0xf bank_mask:0xf
  s_waitcnt vmcnt(6)
  s_cmp_gt_u32 s101, 5
  s_cbranch_scc1 L_cw_127
  s_waitcnt vmcnt(5)
  s_cmp_eq_u32 s101, 5
  s_cbranch_scc1 L_cw_127
  s_waitcnt vmcnt(4)
L_cw_127:
  buffer_load_dwordx4 v[88:91], v1, s[40:43], s64 offen nt
  s_add_u32 s64, s64, 4096
  v_add_u32 v56, 1, v56
  ds_write_b32 v57, v56 offset:29184
  s_waitcnt vmcnt(6)
  v_dot2c_f32_bf16_dpp v8, v16, v64 row_newbcast:8 row_mask:0xf bank_mask:0xf
  v_dot2c_f32_bf16_dpp v9, v17, v64 row_newbcast:8 row_mask:0xf bank_mask:0xf
  v_dot2c_f32_bf16_dpp v10, v16, v65 row_newbcast:8 row_mask:0xf bank_mask:0xf
  v_dot2c_f32_bf16_dpp v11, v17, v65 row_newbcast:8 row_mask:0xf bank_mask:0xf
  v_dot2c_f32_bf16_dpp v12, v16, v66 row_newbcast:8 row_mask:0xf bank_mask:0xf
  v_dot2c_f32_bf16_dpp v13, v17, v66 row_newbcast:8 row_mask:0xf bank_mask:0xf
  v_dot2c_f32_bf16_dpp v14, v16, v67 row_newbcast:8 row_mask:0xf bank_mask:0xf
  v_dot2c_f32_bf16_dpp v15, v17, v67 row_newbcast:8 row_mask:0xf bank_mask:0xf
  s_waitcnt vmcnt(6)
  s_cmp_gt_u32 s101, 5
  s_cbranch_scc1 L_cw_128
  s_waitcnt vmcnt(5)
  s_cmp_eq_u32 s101, 5
  s_cbranch_scc1 L_cw_128
  s_waitcnt vmcnt(4)
L_cw_128:
  buffer_load_dwordx4 v[92:95], v1, s[40:43], s64 offen nt
  s_add_u32 s64, s64, 4096
  s_waitcnt vmcnt(6)
  v_dot2c_f32_bf16_dpp v8, v16, v68 row_newbcast:9 row_mask:0xf bank_mask:0xf
  v_dot2c_f32_bf16_dpp v9, v17, v68 row_newbcast:9 row_mask:0xf bank_mask:0xf
  v_dot2c_f32_bf16_dpp v10, v16, v69 row_newbcast:9 row_mask:0xf bank_mask:0xf
  v_dot2c_f32_bf16_dpp v11, v17, v69 row_newbcast:9 row_mask:0xf bank_mask:0xf
  v_dot2c_f32_bf16_dpp v12, v16, v70 row_newbcast:9 row_mask:0xf bank_mask:0xf
  v_dot2c_f32_bf16_dpp v13, v17, v70 row_newbcast:9 row_mask:0xf bank_mask:0xf
  v_dot2c_f32_bf16_dpp v14, v16, v71 row_newbcast:9 row_mask:0xf bank_mask:0xf
  v_dot2c_f32_bf16_dpp v15, v17, v71 row_newbcast:9 row_mask:0xf bank_mask:0xf
  v_add_u32 v56, 1, v56
  ds_write_b32 v57, v56 offset:29184
  s_waitcnt vmcnt(5)
  v_dot2c_f32_bf16_dpp v8, v16, v72 row_newbcast:10 row_mask:0xf bank_mask:0xf
  v_dot2c_f32_bf16_dpp v9, v17, v72 row_newbcast:10 row_mask:0xf bank_mask:0xf
  v_dot2c_f32_bf16_dpp v10, v16, v73 row_newbcast:10 row_mask:0xf bank_mask:0xf
  v_dot2c_f32_bf16_dpp v11, v17, v73 row_newbcast:10 row_mask:0xf bank_mask:0xf
  v_dot2c_f32_bf16_dpp v12, v16, v74 row_newbcast:10 row_mask:0xf bank_mask:0xf
  v_dot2c_f32_bf16_dpp v13, v17, v74 row_newbcast:10 row_mask:0xf bank_mask:0xf
  v_dot2c_f32_bf16_dpp v14, v16, v75 row_newbcast:10 row_mask:0xf bank_mask:0xf
  v_dot2c_f32_bf16_dpp v15, v17, v75 row_newbcast:10 row_mask:0xf bank_mask:0xf
  ds_read_b64 v[44:45], v48 offset:20544
  s_waitcnt vmcnt(4)
  v_dot2c_f32_bf16_dpp v8, v16, v76 row_newbcast:11 row_mask:0xf bank_mask:0xf
  v_dot2c_f32_bf16_dpp v9, v17, v76 row_newbcast:11 row_mask:0xf bank_mask:0xf
  v_dot2c_f32_bf16_dpp v10, v16, v77 row_newbcast:11 row_mask:0xf bank_mask:0xf
  v_dot2c_f32_bf16_dpp v11, v17, v77 row_newbcast:11 row_mask:0xf bank_mask:0xf
  v_dot2c_f32_bf16_dpp v12, v16, v78 row_newbcast:11 row_mask:0xf bank_mask:0xf
  v_dot2c_f32_bf16_dpp v13, v17, v78 row_newbcast:11 row_mask:0xf bank_mask:0xf
  v_dot2c_f32_bf16_dpp v14, v16, v79 row_newbcast:11 row_mask:0xf bank_mask:0xf
  v_dot2c_f32_bf16_dpp v15, v17, v79 row_newbcast:11 row_mask:0xf bank_mask:0xf
  v_add_u32 v56, 1, v56
  ds_write_b32 v57, v56 offset:29184
  s_waitcnt vmcnt(3)
  v_dot2c_f32_bf16_dpp v8, v16, v80 row_newbcast:12 row_mask:0xf bank_mask:0xf
  v_dot2c_f32_bf16_dpp v9, v17, v80 row_newbcast:12 row_mask:0xf bank_mask:0xf
  v_dot2c_f32_bf16_dpp v10, v16, v81 row_newbcast:12 row_mask:0xf bank_mask:0xf
  v_dot2c_f32_bf16_dpp v11, v17, v81 row_newbcast:12 row_mask:0xf bank_mask:0xf
  v_dot2c_f32_bf16_dpp v12, v16, v82 row_newbcast:12 row_mask:0xf bank_mask:0xf
  v_dot2c_f32_bf16_dpp v13, v17, v82 row_newbcast:12 row_mask:0xf bank_mask:0xf
  v_dot2c_f32_bf16_dpp v14, v16, v83 row_newbcast:12 row_mask:0xf bank_mask:0xf
  v_dot2c_f32_bf16_dpp v15, v17, v83 row_newbcast:12 row_mask:0xf bank_mask:0xf
  s_waitcnt vmcnt(2)
  v_dot2c_f32_bf16_dpp v8, v16, v84 row_newbcast:13 row_mask:0xf bank_mask:0xf
  v_dot2c_f32_bf16_dpp v9, v17, v84 row_newbcast:13 row_mask:0xf bank_mask:0xf
  v_dot2c_f32_bf16_dpp v10, v16, v85 row_newbcast:13 row_mask:0xf bank_mask:0xf
  v_dot2c_f32_bf16_dpp v11, v17, v85 row_newbcast:13 row_mask:0xf bank_mask:0xf
  v_dot2c_f32_bf16_dpp v12, v16, v86 row_newbcast:13 row_mask:0xf bank_mask:0xf
  v_dot2c_f32_bf16_dpp v13, v17, v86 row_newbcast:13 row_mask:0xf bank_mask:0xf
  v_dot2c_f32_bf16_dpp v14, v16, v87 row_newbcast:13 row_mask:0xf bank_mask:0xf
  v_dot2c_f32_bf16_dpp v15, v17, v87 row_newbcast:13 row_mask:0xf bank_mask:0xf
  v_add_u32 v56, 1, v56
  ds_write_b32 v57, v56 offset:29184
  s_waitcnt vmcnt(1)
  v_dot2c_f32_bf16_dpp v8, v16, v88 row_newbcast:14 row_mask:0xf bank_mask:0xf
  v_dot2c_f32_bf16_dpp v9, v17, v88 row_newbcast:14 row_mask:0xf bank_mask:0xf
  v_dot2c_f32_bf16_dpp v10, v16, v89 row_newbcast:14 row_mask:0xf bank_mask:0xf
  v_dot2c_f32_bf16_dpp v11, v17, v89 row_newbcast:14 row_mask:0xf bank_mask:0xf
  v_dot2c_f32_bf16_dpp v12, v16, v90 row_newbcast:14 row_mask:0xf bank_mask:0xf
  v_dot2c_f32_bf16_dpp v13, v17, v90 row_newbcast:14 row_mask:0xf bank_mask:0xf
  v_dot2c_f32_bf16_dpp v14, v16, v91 row_newbcast:14 row_mask:0xf bank_mask:0xf
  v_dot2c_f32_bf16_dpp v15, v17, v91 row_newbcast:14 row_mask:0xf bank_mask:0xf
  s_waitcnt vmcnt(0)
  v_dot2c_f32_bf16_dpp v8, v16, v92 row_newbcast:15 row_mask:0xf bank_mask:0xf
  v_dot2c_f32_bf16_dpp v9, v17, v92 row_newbcast:15 row_mask:0xf bank_mask:0xf
  v_dot2c_f32_bf16_dpp v10, v16, v93 row_newbcast:15 row_mask:0xf bank_mask:0xf
  v_dot2c_f32_bf16_dpp v11, v17, v93 row_newbcast:15 row_mask:0xf bank_mask:0xf
  v_dot2c_f32_bf16_dpp v12, v16, v94 row_newbcast:15 row_mask:0xf bank_mask:0xf
  v_dot2c_f32_bf16_dpp v13, v17, v94 row_newbcast:15 row_mask:0xf bank_mask:0xf
  v_dot2c_f32_bf16_dpp v14, v16, v95 row_newbcast:15 row_mask:0xf bank_mask:0xf
  v_dot2c_f32_bf16_dpp v15, v17, v95 row_newbcast:15 row_mask:0xf bank_mask:0xf
  v_add_u32 v56, 1, v56
  ds_write_b32 v57, v56 offset:29184
  v_permlane32_swap_b32 v8, v12
  v_permlane32_swap_b32 v9, v13
  v_permlane32_swap_b32 v10, v14
  v_permlane32_swap_b32 v11, v15
  v_add_f32 v8, v8, v12
  v_add_f32 v9, v9, v13
  v_add_f32 v10, v10, v14
  v_add_f32 v11, v11, v15
  s_nop 0
  v_permlane16_swap_b32 v8, v10
  v_permlane16_swap_b32 v9, v11
  v_add_f32 v8, v8, v10
  v_add_f32 v9, v9, v11
  s_waitcnt lgkmcnt(0)
  v_cmp_ne_u32 vcc, 1, v45
  s_nop 0
  s_cmp_eq_u64 vcc, 0
  s_cbranch_scc1 L_cw_ok
  s_mov_b32 s86, 0
L_poll_129:
  ds_read_b64 v[44:45], v48 offset:20544
  s_waitcnt lgkmcnt(0)
  v_cmp_ne_u32 vcc, 1, v45
  s_nop 0
  s_cmp_eq_u64 vcc, 0
  s_cbranch_scc1 L_pok_130
  s_add_u32 s86, s86, 1
  s_cmp_gt_u32 s86, 0x20000
  s_cbranch_scc1 L_pok_130
  s_sleep 1
  s_branch L_poll_129
L_pok_130:
L_cw_ok:
  v_mul_f32 v8, v8, v44
  v_mul_f32 v9, v9, v44
  v_mov_b32 v49, 1
  ds_write_b64 v39, v[8:9] offset:0
  ds_write_b32 v57, v49 offset:29248
  s_cmp_lt_u32 s89, 43
  s_cbranch_scc1 L_S3
L_S_fin:
  s_endpgm
L_S3:
  s_mov_b32 s84, s3
  v_lshrrev_b32 v46, 2, v2
  s_mov_b32 s70, 2752
  v_mul_lo_u32 v46, v46, s70
  v_and_b32 v47, 3, v2
  v_lshl_add_u32 v46, v47, 4, v46
  s_mul_i32 s70, s84, 352256
  s_lshl_b32 s73, s89, 6
  s_add_u32 s70, s70, s73
  v_lshlrev_b32 v48, 4, v2
  s_lshl_b32 s71, s84, 14
  s_add_u32 s71, s71, 46080
  v_add_u32 v48, s71, v48
  v_mov_b32 v49, 0
  s_mov_b32 s86, 0
L_poll_131:
  ds_read_b32 v50, v49 offset:29264
  s_waitcnt lgkmcnt(0)
  v_cmp_ne_u32 vcc, 1, v50
  s_nop 0
  s_cmp_eq_u64 vcc, 0
  s_cbranch_scc1 L_pok_132
  s_add_u32 s86, s86, 1
  s_cmp_gt_u32 s86, 0x20000
  s_cbranch_scc1 L_pok_132
  s_sleep 1
  s_branch L_poll_131
L_pok_132:
  s_mov_b32 s56, s28
  s_mov_b32 s57, s29
  s_mov_b32 s58, 1409024
  s_mov_b32 s59, 0x20000
  s_add_u32 s72, s70, 0
  buffer_load_dwordx4 v[160:163], v46, s[56:59], s72 offen nt
  s_add_u32 s72, s70, 44032
  buffer_load_dwordx4 v[164:167], v46, s[56:59], s72 offen nt
  s_add_u32 s72, s70, 88064
  buffer_load_dwordx4 v[168:171], v46, s[56:59], s72 offen nt
  s_add_u32 s72, s70, 132096
  buffer_load_dwordx4 v[172:175], v46, s[56:59], s72 offen nt
  s_add_u32 s72, s70, 176128
  buffer_load_dwordx4 v[176:179], v46, s[56:59], s72 offen nt
  s_add_u32 s72, s70, 220160
  buffer_load_dwordx4 v[180:183], v46, s[56:59], s72 offen nt
  s_add_u32 s72, s70, 264192
  buffer_load_dwordx4 v[184:187], v46, s[56:59], s72 offen nt
  s_add_u32 s72, s70, 308224
  buffer_load_dwordx4 v[188:191], v46, s[56:59], s72 offen nt
  s_mov_b32 s56, s30
  s_mov_b32 s57, s31
  s_mov_b32 s58, 1409024
  s_mov_b32 s59, 0x20000
  s_add_u32 s72, s70, 0
  buffer_load_dwordx4 v[192:195], v46, s[56:59], s72 offen nt
  s_add_u32 s72, s70, 44032
  buffer_load_dwordx4 v[196:199], v46, s[56:59], s72 offen nt
  s_add_u32 s72, s70, 88064
  buffer_load_dwordx4 v[200:203], v46, s[56:59], s72 offen nt
  s_add_u32 s72, s70, 132096
  buffer_load_dwordx4 v[204:207], v46, s[56:59], s72 offen nt
  s_add_u32 s72, s70, 176128
  buffer_load_dwordx4 v[208:211], v46, s[56:59], s72 offen nt
  s_add_u32 s72, s70, 220160
  buffer_load_dwordx4 v[212:215], v46, s[56:59], s72 offen nt
  s_add_u32 s72, s70, 264192
  buffer_load_dwordx4 v[216:219], v46, s[56:59], s72 offen nt
  s_add_u32 s72, s70, 308224
  buffer_load_dwordx4 v[220:223], v46, s[56:59], s72 offen nt
  s_waitcnt vmcnt(15)
  ds_write_b128 v48, v[160:163] offset:0
  s_waitcnt vmcnt(14)
  ds_write_b128 v48, v[164:167] offset:1024
  s_waitcnt vmcnt(13)
  ds_write_b128 v48, v[168:171] offset:2048
  s_waitcnt vmcnt(12)
  ds_write_b128 v48, v[172:175] offset:3072
  s_waitcnt vmcnt(11)
  ds_write_b128 v48, v[176:179] offset:4096
  s_waitcnt vmcnt(10)
  ds_write_b128 v48, v[180:183] offset:5120
  s_waitcnt vmcnt(9)
  ds_write_b128 v48, v[184:187] offset:6144
  s_waitcnt vmcnt(8)
  ds_write_b128 v48, v[188:191] offset:7168
  s_lshl_b32 s70, s84, 2
  v_mov_b32 v49, s70
  v_mov_b32 v50, 1
  ds_write_b32 v49, v50 offset:29280
  s_waitcnt vmcnt(7)
  ds_write_b128 v48, v[192:195] offset:8192
  s_waitcnt vmcnt(6)
  ds_write_b128 v48, v[196:199] offset:9216
  s_waitcnt vmcnt(5)
  ds_write_b128 v48, v[200:203] offset:10240
  s_waitcnt vmcnt(4)
  ds_write_b128 v48, v[204:207] offset:11264
  s_waitcnt vmcnt(3)
  ds_write_b128 v48, v[208:211] offset:12288
  s_waitcnt vmcnt(2)
  ds_write_b128 v48, v[212:215] offset:13312
  s_waitcnt vmcnt(1)
  ds_write_b128 v48, v[216:219] offset:14336
  s_waitcnt vmcnt(0)
  ds_write_b128 v48, v[220:223] offset:15360
  v_lshrrev_b32 v47, 2, v37
  v_lshl_add_u32 v47, v36, 3, v47
  v_lshlrev_b32 v47, 6, v47
  v_and_b32 v48, 3, v37
  v_lshl_add_u32 v47, v48, 3, v47
  s_lshl_b32 s70, s84, 14
  s_add_u32 s70, s70, 46080
  v_add_u32 v47, s70, v47
  ds_read_b64_tr_b16 v[116:117], v47 offset:0
  ds_read_b64_tr_b16 v[118:119], v47 offset:256
  ds_read_b64_tr_b16 v[120:121], v47 offset:2048
  ds_read_b64_tr_b16 v[122:123], v47 offset:2304
  ds_read_b64_tr_b16 v[124:125], v47 offset:4096
  ds_read_b64_tr_b16 v[126:127], v47 offset:4352
  ds_read_b64_tr_b16 v[128:129], v47 offset:6144
  ds_read_b64_tr_b16 v[130:131], v47 offset:6400
  ds_read_b64_tr_b16 v[132:133], v47 offset:32
  ds_read_b64_tr_b16 v[134:135], v47 offset:288
  ds_read_b64_tr_b16 v[136:137], v47 offset:2080
  ds_read_b64_tr_b16 v[138:139], v47 offset:2336
  ds_read_b64_tr_b16 v[140:141], v47 offset:4128
  ds_read_b64_tr_b16 v[142:143], v47 offset:4384
  ds_read_b64_tr_b16 v[144:145], v47 offset:6176
  ds_read_b64_tr_b16 v[146:147], v47 offset:6432
  ds_read_b64_tr_b16 v[148:149], v47 offset:8192
  ds_read_b64_tr_b16 v[150:151], v47 offset:8448
  ds_read_b64_tr_b16 v[152:153], v47 offset:10240
  ds_read_b64_tr_b16 v[154:155], v47 offset:10496
  ds_read_b64_tr_b16 v[156:157], v47 offset:12288
  ds_read_b64_tr_b16 v[158:159], v47 offset:12544
  ds_read_b64_tr_b16 v[160:161], v47 offset:14336
  ds_read_b64_tr_b16 v[162:163], v47 offset:14592
  ds_read_b64_tr_b16 v[164:165], v47 offset:8224
  ds_read_b64_tr_b16 v[166:167], v47 offset:8480
  ds_read_b64_tr_b16 v[168:169], v47 offset:10272
  ds_read_b64_tr_b16 v[170:171], v47 offset:10528
  ds_read_b64_tr_b16 v[172:173], v47 offset:12320
  ds_read_b64_tr_b16 v[174:175], v47 offset:12576
  ds_read_b64_tr_b16 v[176:177], v47 offset:14368
  ds_read_b64_tr_b16 v[178:179], v47 offset:14624
  s_waitcnt lgkmcnt(0)
  s_mov_b32 s90, 0x00ff00ff
  s_mov_b32 s91, 0x00ff00ff
  v_lshrrev_b32 v48, 3, v37
  v_lshl_add_u32 v48, v36, 1, v48
  v_lshlrev_b32 v48, 6, v48
  v_and_b32 v49, 7, v37
  v_lshl_add_u32 v48, v49, 2, v48
  v_lshlrev_b32 v49, 7, v36
  v_add_u32 v50, 32, v49
  v_add_u32 v49, 96, v49
  v_cndmask_b32 v97, v48, v49, s[90:91]
  v_cndmask_b32 v96, v50, v48, s[90:91]
  v_lshl_add_u32 v99, v36, 4, v37
  s_lshl_b32 s70, s3, 6
  v_add_u32 v99, s70, v99
  v_lshlrev_b32 v99, 1, v99
  s_lshl_b32 s99, s3, 9
  s_add_u32 s99, s99, 24576
  s_mov_b32 s48, s34
  s_mov_b32 s49, s35
  s_mov_b32 s50, 4096
  s_mov_b32 s51, 0x20000
  v_and_b32 v114, 3, v37
  v_lshlrev_b32 v114, 6, v114
  v_lshl_add_u32 v114, v36, 4, v114
  v_and_b32 v46, 1, v2
  v_lshlrev_b32 v46, 2, v46
  s_mov_b32 s86, 0
L_poll_133:
  ds_read_b32 v47, v46 offset:29240
  s_waitcnt lgkmcnt(0)
  v_cmp_ne_u32 vcc, 1, v47
  s_nop 0
  s_cmp_eq_u64 vcc, 0
  s_cbranch_scc1 L_pok_134
  s_add_u32 s86, s86, 1
  s_cmp_gt_u32 s86, 0x20000
  s_cbranch_scc1 L_pok_134
  s_sleep 2
  s_branch L_poll_133
L_pok_134:
  v_lshrrev_b32 v47, 2, v37
  v_lshl_add_u32 v47, v36, 3, v47
  s_mov_b32 s70, 1056
  v_mul_lo_u32 v47, v47, s70
  v_and_b32 v48, 3, v37
  v_lshl_add_u32 v47, v48, 3, v47
  s_lshl_b32 s70, s3, 7
  s_add_u32 s70, s70, 111616
  v_add_u32 v47, s70, v47
  ds_read_b64_tr_b16 v[232:233], v47 offset:0
  ds_read_b64_tr_b16 v[234:235], v47 offset:4224
  ds_read_b64_tr_b16 v[236:237], v47 offset:32
  ds_read_b64_tr_b16 v[238:239], v47 offset:4256
  ds_read_b64_tr_b16 v[240:241], v47 offset:64
  ds_read_b64_tr_b16 v[242:243], v47 offset:4288
  ds_read_b64_tr_b16 v[244:245], v47 offset:96
  ds_read_b64_tr_b16 v[246:247], v47 offset:4320
  v_lshlrev_b32 v46, 4, v2
  s_mul_i32 s72, s84, 1088
  v_add_u32 v108, s72, v46
  s_lshl_b32 s73, s84, 10
  v_add_u32 v109, s73, v46
  v_and_b32 v110, 3, v37
  v_mul_u32_u24 v110, 1088, v110
  v_lshl_add_u32 v110, v36, 4, v110
  s_lshl_b32 s72, s84, 8
  v_add_u32 v110, s72, v110
  s_mul_i32 s73, s84, 1024
  v_lshlrev_b32 v111, 4, v37
  v_lshl_add_u32 v112, v36, 2, v111
  v_add_u32 v112, s72, v112
  v_add_u32 v111, s73, v111
  v_lshlrev_b32 v113, 6, v36
  v_lshl_add_u32 v113, v37, 1, v113
  s_lshl_b32 s72, s84, 5
  v_add_u32 v113, s72, v113
  s_lshl_b32 s70, s84, 11
  s_add_u32 s70, s70, 2424832
  s_mov_b32 s86, 0
L_npoll_135:
  buffer_load_dwordx4 v[64:67], v46, s[52:55], s70 offen sc1
  buffer_load_dwordx4 v[68:71], v46, s[52:55], s70 offen offset:1024 sc1
  s_waitcnt vmcnt(0)
  v_xor_b32 v61, s81, v65
  v_bitop3_b32 v61, v61, v67, s81 bitop3:0xf6
  v_bitop3_b32 v61, v61, v69, s81 bitop3:0xf6
  v_bitop3_b32 v61, v61, v71, s81 bitop3:0xf6
  v_cmp_ne_u32 vcc, 0, v61
  s_nop 0
  s_cmp_eq_u64 vcc, 0
  s_cbranch_scc1 L_npok_136
  s_mov_b64 exec, vcc
  s_add_u32 s86, s86, 1
  s_sleep 1
  s_cmp_le_u32 s86, 0x20000
  s_cbranch_scc1 L_npoll_135
L_npok_136:
  s_mov_b64 exec, -1
  v_lshlrev_b32 v52, 16, v64
  v_and_b32 v53, 0xffff0000, v64
  v_lshlrev_b32 v54, 16, v66
  v_and_b32 v55, 0xffff0000, v66
  v_lshlrev_b32 v56, 16, v68
  v_and_b32 v57, 0xffff0000, v68
  v_lshlrev_b32 v58, 16, v70
  v_and_b32 v59, 0xffff0000, v70
  v_add_f32 v30, v52, v53
  v_add_f32 v31, v54, v55
  v_add_f32 v32, v56, v57
  v_add_f32 v28, v58, v59
  v_add_f32 v30, v30, v31
  v_add_f32 v32, v32, v28
  v_add_f32 v28, v30, v32
  s_nop 1
  v_add_f32_dpp v28, v28, v28 row_ror:8 row_mask:0xf bank_mask:0xf
  s_nop 1
  v_add_f32_dpp v28, v28, v28 row_ror:4 row_mask:0xf bank_mask:0xf
  s_nop 1
  v_add_f32_dpp v28, v28, v28 row_ror:2 row_mask:0xf bank_mask:0xf
  s_nop 1
  v_add_f32_dpp v28, v28, v28 row_ror:1 row_mask:0xf bank_mask:0xf
  v_mov_b32 v30, v28
  s_nop 1
  v_permlane16_swap_b32 v28, v30
  v_add_f32 v28, v28, v30
  v_mov_b32 v30, v28
  s_nop 1
  v_permlane32_swap_b32 v28, v30
  v_add_f32 v28, v28, v30
  v_mul_f32 v28, 0x3b000000, v28
  v_sub_f32 v30, v52, v28
  v_mul_f32 v29, v30, v30
  v_sub_f32 v30, v53, v28
  v_fmac_f32 v29, v30, v30
  v_sub_f32 v30, v54, v28
  v_fmac_f32 v29, v30, v30
  v_sub_f32 v30, v55, v28
  v_fmac_f32 v29, v30, v30
  v_sub_f32 v30, v56, v28
  v_fmac_f32 v29, v30, v30
  v_sub_f32 v30, v57, v28
  v_fmac_f32 v29, v30, v30
  v_sub_f32 v30, v58, v28
  v_fmac_f32 v29, v30, v30
  v_sub_f32 v30, v59, v28
  v_fmac_f32 v29, v30, v30
  s_nop 1
  v_add_f32_dpp v29, v29, v29 row_ror:8 row_mask:0xf bank_mask:0xf
  s_nop 1
  v_add_f32_dpp v29, v29, v29 row_ror:4 row_mask:0xf bank_mask:0xf
  s_nop 1
  v_add_f32_dpp v29, v29, v29 row_ror:2 row_mask:0xf bank_mask:0xf
  s_nop 1
  v_add_f32_dpp v29, v29, v29 row_ror:1 row_mask:0xf bank_mask:0xf
  v_mov_b32 v30, v29
  s_nop 1
  v_permlane16_swap_b32 v29, v30
  v_add_f32 v29, v29, v30
  v_mov_b32 v30, v29
  s_nop 1
  v_permlane32_swap_b32 v29, v30
  v_add_f32 v29, v29, v30
  v_mul_f32 v29, 0x3b000000, v29
  v_cvt_pk_bf16_f32 v29, v29, v29
  v_lshlrev_b32 v29, 16, v29
  v_add_f32 v29, 0x3727c5ac, v29
  v_cvt_pk_bf16_f32 v29, v29, v29
  v_lshlrev_b32 v29, 16, v29
  v_sqrt_f32 v29, v29
  s_nop 0
  v_cvt_pk_bf16_f32 v29, v29, v29
  v_lshlrev_b32 v29, 16, v29
  v_cvt_pk_bf16_f32 v28, v28, v28
  v_lshlrev_b32 v28, 16, v28
  v_sub_f32 v52, v52, v28
  v_sub_f32 v53, v53, v28
  v_sub_f32 v54, v54, v28
  v_sub_f32 v55, v55, v28
  v_sub_f32 v56, v56, v28
  v_sub_f32 v57, v57, v28
  v_sub_f32 v58, v58, v28
  v_sub_f32 v59, v59, v28
  v_rcp_f32 v30, v29
  v_cvt_pk_bf16_f32 v52, v52, v52
  v_lshlrev_b32 v52, 16, v52
  v_cvt_pk_bf16_f32 v53, v53, v53
  v_lshlrev_b32 v53, 16, v53
  v_cvt_pk_bf16_f32 v54, v54, v54
  v_lshlrev_b32 v54, 16, v54
  v_cvt_pk_bf16_f32 v55, v55, v55
  v_lshlrev_b32 v55, 16, v55
  v_cvt_pk_bf16_f32 v56, v56, v56
  v_lshlrev_b32 v56, 16, v56
  v_cvt_pk_bf16_f32 v57, v57, v57
  v_lshlrev_b32 v57, 16, v57
  v_cvt_pk_bf16_f32 v58, v58, v58
  v_lshlrev_b32 v58, 16, v58
  v_cvt_pk_bf16_f32 v59, v59, v59
  v_lshlrev_b32 v59, 16, v59
  v_mul_f32 v20, v52, v30
  v_mul_f32 v21, v53, v30
  v_mul_f32 v22, v54, v30
  v_mul_f32 v23, v55, v30
  v_mul_f32 v24, v56, v30
  v_mul_f32 v25, v57, v30
  v_mul_f32 v26, v58, v30
  v_mul_f32 v27, v59, v30
  v_fma_f32 v8, -v20, v29, v52
  v_fma_f32 v9, -v21, v29, v53
  v_fma_f32 v10, -v22, v29, v54
  v_fma_f32 v11, -v23, v29, v55
  v_fma_f32 v12, -v24, v29, v56
  v_fma_f32 v13, -v25, v29, v57
  v_fma_f32 v14, -v26, v29, v58
  v_fma_f32 v15, -v27, v29, v59
  v_fma_f32 v52, v8, v30, v20
  v_fma_f32 v53, v9, v30, v21
  v_fma_f32 v54, v10, v30, v22
  v_fma_f32 v55, v11, v30, v23
  v_fma_f32 v56, v12, v30, v24
  v_fma_f32 v57, v13, v30, v25
  v_fma_f32 v58, v14, v30, v26
  v_fma_f32 v59, v15, v30, v27
  v_cvt_pk_bf16_f32 v20, v52, v53
  v_cvt_pk_bf16_f32 v21, v54, v55
  v_cvt_pk_bf16_f32 v22, v56, v57
  v_cvt_pk_bf16_f32 v23, v58, v59
  ds_write_b128 v108, v[20:23] offset:20672
  v_mov_b32 v72, v64
  v_mov_b32 v73, v66
  v_mov_b32 v74, v68
  v_mov_b32 v75, v70
  ds_write_b128 v109, v[72:75] offset:4096
  s_waitcnt lgkmcnt(0)
  s_barrier
  ds_read_b128 v[192:195], v110 offset:20672
  ds_read_b128 v[196:199], v110 offset:20736
  ds_read_b128 v[200:203], v110 offset:20800
  ds_read_b128 v[204:207], v110 offset:20864
  s_waitcnt lgkmcnt(3)
  v_mfma_f32_16x16x32_bf16 v[20:23], v[192:195], v[116:119], 0
  v_mfma_f32_16x16x32_bf16 v[24:27], v[192:195], v[132:135], 0
  v_mfma_f32_16x16x32_bf16 v[28:31], v[192:195], v[148:151], 0
  v_mfma_f32_16x16x32_bf16 v[32:35], v[192:195], v[164:167], 0
  s_waitcnt lgkmcnt(2)
  v_mfma_f32_16x16x32_bf16 v[20:23], v[196:199], v[120:123], v[20:23]
  v_mfma_f32_16x16x32_bf16 v[24:27], v[196:199], v[136:139], v[24:27]
  v_mfma_f32_16x16x32_bf16 v[28:31], v[196:199], v[152:155], v[28:31]
  v_mfma_f32_16x16x32_bf16 v[32:35], v[196:199], v[168:171], v[32:35]
  s_waitcnt lgkmcnt(1)
  v_mfma_f32_16x16x32_bf16 v[20:23], v[200:203], v[124:127], v[20:23]
  v_mfma_f32_16x16x32_bf16 v[24:27], v[200:203], v[140:143], v[24:27]
  v_mfma_f32_16x16x32_bf16 v[28:31], v[200:203], v[156:159], v[28:31]
  v_mfma_f32_16x16x32_bf16 v[32:35], v[200:203], v[172:175], v[32:35]
  s_waitcnt lgkmcnt(0)
  v_mfma_f32_16x16x32_bf16 v[20:23], v[204:207], v[128:131], v[20:23]
  v_mfma_f32_16x16x32_bf16 v[24:27], v[204:207], v[144:147], v[24:27]
  v_mfma_f32_16x16x32_bf16 v[28:31], v[204:207], v[160:163], v[28:31]
  v_mfma_f32_16x16x32_bf16 v[32:35], v[204:207], v[176:179], v[32:35]
  s_mov_b64 exec, 0xffff
  s_nop 3
  ds_write_b128 v111, v[20:23] offset:25024
  ds_write_b128 v111, v[24:27] offset:25280
  ds_write_b128 v111, v[28:31] offset:25536
  ds_write_b128 v111, v[32:35] offset:25792
  s_mov_b64 exec, -1
  s_waitcnt lgkmcnt(0)
  s_barrier
  s_cmp_ge_u32 s84, 2
  s_cbranch_scc1 L_barC
  ds_read_b32 v208, v112 offset:25024
  ds_read_b32 v216, v112 offset:25536
  ds_read_b32 v209, v112 offset:26048
  ds_read_b32 v217, v112 offset:26560
  ds_read_b32 v210, v112 offset:27072
  ds_read_b32 v218, v112 offset:27584
  ds_read_b32 v211, v112 offset:28096
  ds_read_b32 v219, v112 offset:28608
  s_waitcnt lgkmcnt(0)
  v_add_f32 v208, v208, v209
  v_add_f32 v210, v210, v211
  v_add_f32 v216, v216, v217
  v_add_f32 v218, v218, v219
  v_add_f32 v208, v208, v210
  v_add_f32 v216, v216, v218
  v_cvt_pk_bf16_f32 v208, v208, v208
  v_lshlrev_b32 v208, 16, v208
  v_cvt_pk_bf16_f32 v216, v216, v216
  v_lshlrev_b32 v216, 16, v216
  v_mul_f32 v224, v208, v208
  v_mul_f32 v224, v224, v208
  v_mov_b32 v225, 0x3d372713
  v_fma_f32 v224, v224, v225, v208
  v_mul_f32 v224, 0xc0135761, v224
  v_exp_f32 v224, v224
  s_nop 0
  v_add_f32 v224, 1.0, v224
  v_rcp_f32 v225, v224
  s_nop 0
  v_mul_f32 v226, v208, v225
  v_fma_f32 v227, -v226, v224, v208
  v_fma_f32 v208, v227, v225, v226
  v_cvt_pk_bf16_f32 v208, v208, v208
  v_lshlrev_b32 v208, 16, v208
  v_mul_f32 v208, v208, v216
  v_cvt_pk_bf16_f32 v208, v208, v208
  ds_write_b16 v113, v208 offset:8192
L_barC:
  ds_read_u16 v92, v99 offset:4096
  ds_read_u16 v93, v99 offset:5120
  ds_read_u16 v94, v99 offset:6144
  ds_read_u16 v95, v99 offset:7168
  s_waitcnt lgkmcnt(0)
  s_barrier
  ds_read_b128 v[80:83], v114 offset:8192
  v_lshlrev_b32 v92, 16, v92
  v_lshlrev_b32 v93, 16, v93
  v_lshlrev_b32 v94, 16, v94
  v_lshlrev_b32 v95, 16, v95
  s_waitcnt lgkmcnt(0)
  v_mfma_f32_16x16x32_bf16 v[64:67], v[80:83], v[232:235], 0
  v_mfma_f32_16x16x32_bf16 v[68:71], v[80:83], v[236:239], 0
  v_mfma_f32_16x16x32_bf16 v[72:75], v[80:83], v[240:243], 0
  v_mfma_f32_16x16x32_bf16 v[76:79], v[80:83], v[244:247], 0
  s_add_u32 s70, s99, 0
  s_add_u32 s71, s99, 4096
  s_add_u32 s72, s99, 8192
  s_add_u32 s73, s99, 12288
  s_mov_b32 s98, 0x42280000
  s_nop 0
  v_mov_b32_dpp v64, v68 quad_perm:[0,1,2,3] row_mask:0x2 bank_mask:0xf
  v_mov_b32_dpp v65, v69 quad_perm:[0,1,2,3] row_mask:0x2 bank_mask:0xf
  v_mov_b32_dpp v66, v70 quad_perm:[0,1,2,3] row_mask:0x2 bank_mask:0xf
  v_mov_b32_dpp v67, v71 quad_perm:[0,1,2,3] row_mask:0x2 bank_mask:0xf
  v_mov_b32_dpp v64, v72 quad_perm:[0,1,2,3] row_mask:0x4 bank_mask:0xf
  v_mov_b32_dpp v65, v73 quad_perm:[0,1,2,3] row_mask:0x4 bank_mask:0xf
  v_mov_b32_dpp v66, v74 quad_perm:[0,1,2,3] row_mask:0x4 bank_mask:0xf
  v_mov_b32_dpp v67, v75 quad_perm:[0,1,2,3] row_mask:0x4 bank_mask:0xf
  v_mov_b32_dpp v64, v76 quad_perm:[0,1,2,3] row_mask:0x8 bank_mask:0xf
  v_mov_b32_dpp v65, v77 quad_perm:[0,1,2,3] row_mask:0x8 bank_mask:0xf
  v_mov_b32_dpp v66, v78 quad_perm:[0,1,2,3] row_mask:0x8 bank_mask:0xf
  v_mov_b32_dpp v67, v79 quad_perm:[0,1,2,3] row_mask:0x8 bank_mask:0xf
  v_cndmask_b32 v84, 1.0, v64, s[90:91]
  v_cndmask_b32 v86, 1.0, v65, s[90:91]
  v_cndmask_b32 v88, 1.0, v66, s[90:91]
  v_cndmask_b32 v90, 1.0, v67, s[90:91]
  s_mov_b32 exec_lo, 0x01ff01ff
  s_mov_b32 exec_hi, 0x01ff01ff
  buffer_atomic_add_f32 v84, v96, s[52:55], s70 offen sc0
  buffer_atomic_add_f32 v86, v96, s[52:55], s71 offen sc0
  buffer_atomic_add_f32 v88, v96, s[52:55], s72 offen sc0
  buffer_atomic_add_f32 v90, v96, s[52:55], s73 offen sc0
  s_mov_b64 exec, -1
  v_mov_b32 v85, 1.0
  v_cndmask_b32 v85, v64, v85, s[90:91]
  v_mov_b32 v87, 1.0
  v_cndmask_b32 v87, v65, v87, s[90:91]
  v_mov_b32 v89, 1.0
  v_cndmask_b32 v89, v66, v89, s[90:91]
  v_mov_b32 v91, 1.0
  v_cndmask_b32 v91, v67, v91, s[90:91]
  s_mov_b32 exec_lo, 0xff80ff80
  s_mov_b32 exec_hi, 0xff80ff80
  buffer_atomic_add_f32 v85, v97, s[52:55], s70 offen sc0
  buffer_atomic_add_f32 v87, v97, s[52:55], s71 offen sc0
  buffer_atomic_add_f32 v89, v97, s[52:55], s72 offen sc0
  buffer_atomic_add_f32 v91, v97, s[52:55], s73 offen sc0
  s_mov_b64 exec, -1
  s_waitcnt vmcnt(0)
  v_mov_b32_dpp v100, v84 row_newbcast:8 row_mask:0xf bank_mask:0x3
  v_mov_b32_dpp v100, v85 row_newbcast:7 row_mask:0xf bank_mask:0xc
  v_mov_b32_dpp v101, v86 row_newbcast:8 row_mask:0xf bank_mask:0x3
  v_mov_b32_dpp v101, v87 row_newbcast:7 row_mask:0xf bank_mask:0xc
  v_mov_b32_dpp v102, v88 row_newbcast:8 row_mask:0xf bank_mask:0x3
  v_mov_b32_dpp v102, v89 row_newbcast:7 row_mask:0xf bank_mask:0xc
  v_mov_b32_dpp v103, v90 row_newbcast:8 row_mask:0xf bank_mask:0x3
  v_mov_b32_dpp v103, v91 row_newbcast:7 row_mask:0xf bank_mask:0xc
  v_cndmask_b32 v84, v85, v84, s[90:91]
  v_add_f32 v64, v64, v84
  v_cvt_pk_bf16_f32 v64, v64, v64
  v_lshlrev_b32 v64, 16, v64
  v_cndmask_b32 v86, v87, v86, s[90:91]
  v_add_f32 v65, v65, v86
  v_cvt_pk_bf16_f32 v65, v65, v65
  v_lshlrev_b32 v65, 16, v65
  v_cndmask_b32 v88, v89, v88, s[90:91]
  v_add_f32 v66, v66, v88
  v_cvt_pk_bf16_f32 v66, v66, v66
  v_lshlrev_b32 v66, 16, v66
  v_cndmask_b32 v90, v91, v90, s[90:91]
  v_add_f32 v67, v67, v90
  v_cvt_pk_bf16_f32 v67, v67, v67
  v_lshlrev_b32 v67, 16, v67
  v_add_f32 v64, v64, v92
  v_cvt_pk_bf16_f32 v64, v64, v64
  v_add_f32 v65, v65, v93
  v_cvt_pk_bf16_f32 v65, v65, v65
  v_add_f32 v66, v66, v94
  v_cvt_pk_bf16_f32 v66, v66, v66
  v_add_f32 v67, v67, v95
  v_cvt_pk_bf16_f32 v67, v67, v67
  v_cmp_eq_u32 vcc, s98, v100
  s_nop 0
  s_and_b32 s75, vcc_lo, 1
  s_cmp_eq_u64 vcc, 0
  s_cbranch_scc1 L_no_137
  s_mov_b64 exec, vcc
  s_mov_b32 s70, 0
  buffer_store_short v64, v99, s[48:51], s70 offen
  s_mov_b64 exec, -1
L_no_137:
  v_cmp_eq_u32 vcc, s98, v101
  s_nop 0
  s_cmp_eq_u64 vcc, 0
  s_cbranch_scc1 L_no_138
  s_mov_b64 exec, vcc
  s_mov_b32 s70, 1024
  buffer_store_short v65, v99, s[48:51], s70 offen
  s_mov_b64 exec, -1
L_no_138:
  v_cmp_eq_u32 vcc, s98, v102
  s_nop 0
  s_cmp_eq_u64 vcc, 0
  s_cbranch_scc1 L_no_139
  s_mov_b64 exec, vcc
  s_mov_b32 s70, 2048
  buffer_store_short v66, v99, s[48:51], s70 offen
  s_mov_b64 exec, -1
L_no_139:
  v_cmp_eq_u32 vcc, s98, v103
  s_nop 0
  s_cmp_eq_u64 vcc, 0
  s_cbranch_scc1 L_no_140
  s_mov_b64 exec, vcc
  s_mov_b32 s70, 3072
  buffer_store_short v67, v99, s[48:51], s70 offen
  s_mov_b64 exec, -1
L_no_140:
  s_cmp_lg_u32 s3, 0
  s_cbranch_scc1 L_H_fin
  s_cmp_eq_u32 s75, 0
  s_cbranch_scc1 L_H_fin
  v_mov_b32 v100, s81
  v_mov_b32 v101, 0
  s_mov_b64 exec, 1
  buffer_store_dword v100, v101, s[52:55], 0 offen offset:0
  s_mov_b64 exec, -1
  s_branch L_S_fin
L_vs_f8:
  v_mov_b32 v46, 0
  v_mov_b32 v47, 1
  ds_write_b32 v46, v47 offset:20640
  s_branch L_vside_done
L_end:
  s_endpgm
L_code_end:
.section .rodata,"a"
.p2align 6
.amdhsa_kernel sequential_preLN__gqa_block_cached__geglu_ffn__decode_kernel
  .amdhsa_next_free_vgpr 256
  .amdhsa_next_free_sgpr 102
  .amdhsa_accum_offset 256
  .amdhsa_group_segment_fixed_size 0
  .amdhsa_kernarg_size 96
  .amdhsa_user_sgpr_count 2
  .amdhsa_user_sgpr_kernarg_segment_ptr 1
  .amdhsa_system_sgpr_workgroup_id_x 1
  .amdhsa_float_denorm_mode_32 3
  .amdhsa_float_denorm_mode_16_64 3
.end_amdhsa_kernel
```
